```python
import torch

def _softmax(x, axis=-1):
    return torch.softmax(x, dim=axis)
def _gelu(x):
    return torch.nn.functional.gelu(x, approximate="tanh")
def _silu(x):
    return torch.nn.functional.silu(x)
def _sigmoid(x):
    return torch.sigmoid(x)
def _layernorm(x, axis=-1, eps=1e-5):
    m = x.mean(dim=axis, keepdim=True)
    v = x.var(dim=axis, keepdim=True, unbiased=False)
    return (x - m) / torch.sqrt(v + eps)
def _scatter_add(tgt, idx, src, axis=0):
    return tgt.clone().index_add_(axis, idx, src)
def _segment_sum(src, seg, n):
    out = torch.zeros((n,) + src.shape[1:], dtype=src.dtype)
    return out.index_add_(0, seg, src)
def _pad(x, pw):
    flat = tuple(v for pair in reversed(pw) for v in pair)
    return torch.nn.functional.pad(x, flat)

kernel_name = 'concat_heads__gqa_block_cached__sliding_block_cached__decode'

def setup_inputs():

    _w = (lambda a: (lambda t: t.to(torch.bfloat16) if t.is_floating_point() else t)(torch.as_tensor(a)))
    def _A_setup():
        B, Sq, D = 1, 1, 640
        Hq, Hkv, Sk, Dh = 32, 32, 4096, 128
        assert Hq % Hkv == 0, (Hq, Hkv)
        return {
            "x": _w((lambda *s: torch.randn(*s, dtype=torch.bfloat16) * 3.2)(B, Sq, D)),
            "k_cache": _w((lambda *s: torch.randn(*s, dtype=torch.bfloat16) * 6.4)(B, Hkv, Sk, Dh)),
            "v_cache": _w((lambda *s: torch.randn(*s, dtype=torch.bfloat16) * 0.1)(B, Hkv, Sk, Dh)),
            "wq": _w((lambda *s: torch.randn(*s, dtype=torch.bfloat16) * 6.4)(D, Hq * Dh) * (D ** -0.5)),
            "wo": _w((lambda *s: torch.randn(*s, dtype=torch.bfloat16) * 0.1)(Hq * Dh, D) * ((Hq * Dh) ** -0.5)),
        }
    _A_in = _A_setup()

    def _B_setup():
        B, Sq, D = 1, 1, 640
        Hq, Hkv, Sk, Dh = 32, 32, 4096, 128
        assert Hq % Hkv == 0, (Hq, Hkv)
        return {
            "x": _w((lambda *s: torch.randn(*s, dtype=torch.bfloat16) * 1.6)(B, Sq, D)),
            "k_cache": _w((lambda *s: torch.randn(*s, dtype=torch.bfloat16) * 3.2)(B, Hkv, Sk, Dh)),
            "v_cache": _w((lambda *s: torch.randn(*s, dtype=torch.bfloat16) * 0.1)(B, Hkv, Sk, Dh)),
            "wq": _w((lambda *s: torch.randn(*s, dtype=torch.bfloat16) * 3.2)(D, Hq * Dh) * (D ** -0.5)),
            "wo": _w((lambda *s: torch.randn(*s, dtype=torch.bfloat16) * 0.1)(Hq * Dh, D) * ((Hq * Dh) ** -0.5)),
        }
    _B_in = _B_setup()

    return {
        "A_x": _A_in["x"],
        "A_k_cache": _A_in["k_cache"],
        "A_v_cache": _A_in["v_cache"],
        "A_wq": _A_in["wq"],
        "A_wo": _A_in["wo"],
        "B_x": _B_in["x"],
        "B_k_cache": _B_in["k_cache"],
        "B_v_cache": _B_in["v_cache"],
        "B_wq": _B_in["wq"],
        "B_wo": _B_in["wo"],
    }

def reference(A_x, A_k_cache, A_v_cache, A_wq, A_wo, B_x, B_k_cache, B_v_cache, B_wq, B_wo):
    def _A_ref(x, k_cache, v_cache, wq, wo):
        B, Sq, D = x.shape
        Hq, Dh = 32, 128
        Hkv = k_cache.shape[1]
        rep = Hq // Hkv
        q = (lambda x, *d: x.permute(*d))((x @ wq).reshape(B, Sq, Hq, Dh), 0, 2, 1, 3)
        k = (lambda x, n, axis: torch.repeat_interleave(x, n, dim=axis))(k_cache, rep, axis=1)
        v = (lambda x, n, axis: torch.repeat_interleave(x, n, dim=axis))(v_cache, rep, axis=1)
        scores = torch.einsum("bhqd,bhkd->bhqk", q, k) * (Dh ** -0.5)
        p = _softmax(scores, axis=-1)
        o = torch.einsum("bhqk,bhkd->bhqd", p, v)
        return (lambda x, *d: x.permute(*d))(o, 0, 2, 1, 3).reshape(B, Sq, Hq * Dh) @ wo

    def _B_ref(x, k_cache, v_cache, wq, wo):
        B, Sq, D = x.shape
        Hq, Dh = 32, 128
        Hkv, Sk = k_cache.shape[1], k_cache.shape[2]
        W = min(4096, max(256, Sk // 4))
        rep = Hq // Hkv
        q = (lambda x, *d: x.permute(*d))((x @ wq).reshape(B, Sq, Hq, Dh), 0, 2, 1, 3)
        k = (lambda x, n, axis: torch.repeat_interleave(x, n, dim=axis))(k_cache[:, :, Sk - W:, :], rep, axis=1)
        v = (lambda x, n, axis: torch.repeat_interleave(x, n, dim=axis))(v_cache[:, :, Sk - W:, :], rep, axis=1)
        scores = torch.einsum("bhqd,bhkd->bhqk", q, k) * (Dh ** -0.5)
        p = _softmax(scores, axis=-1)
        o = torch.einsum("bhqk,bhkd->bhqd", p, v)
        return (lambda x, *d: x.permute(*d))(o, 0, 2, 1, 3).reshape(B, Sq, Hq * Dh) @ wo

    a = _A_ref(A_x, A_k_cache, A_v_cache, A_wq, A_wo)
    b = _B_ref(B_x, B_k_cache, B_v_cache, B_wq, B_wo)
    return torch.concatenate([a, b], axis=-1)
```

```asm
; @launch grid=(256,1,1) block=(512,1,1) lds=22080
.amdgcn_target "amdgcn-amd-amdhsa--gfx950"
.text
.globl concat_heads__gqa_block_cached__sliding_block_cached__decode_kernel
.p2align 8
.type concat_heads__gqa_block_cached__sliding_block_cached__decode_kernel,@function
concat_heads__gqa_block_cached__sliding_block_cached__decode_kernel:
    s_cmp_ge_u32 s2, 256
    s_cbranch_scc1 L_end
    s_load_dwordx16 s[4:19], s[0:1], 0
    s_load_dwordx4 s[20:23], s[0:1], 64
    s_load_dwordx2 s[60:61], s[0:1], 80
    s_load_dwordx2 s[56:57], s[0:1], 96
    v_lshrrev_b32 v1, 6, v0
    v_and_b32 v0, 63, v0
    v_readfirstlane_b32 s30, v1
    s_and_b32 s31, s2, 7
    s_lshr_b32 s35, s2, 3
    s_add_u32 s34, s31, s35
    s_and_b32 s34, s34, 7
    s_getpc_b64 s[66:67]
L_pc:
    s_mov_b32 s64, L_progA2-L_pc
    s_cmp_ge_u32 s34, 4
    s_cselect_b32 s64, L_progA1-L_pc, s64
    s_cmp_ge_u32 s34, 6
    s_cselect_b32 s64, L_progB-L_pc, s64
    s_lshl_b32 s65, s30, 10
    s_add_u32 s64, s64, s65
    v_lshlrev_b32 v48, 4, v0
    v_add_u32 v49, s64, v48
    global_load_dwordx4 v[30:33], v49, s[66:67]
    v_add_u32 v49, L_final-L_pc, v48
    global_load_dwordx4 v[38:41], v49, s[66:67]
    s_cmp_ge_u32 s34, 6
    s_cselect_b32 s24, 1, 0
    s_cmp_ge_u32 s34, 5
    s_cselect_b32 s25, 1, 0
    s_mul_i32 s26, s34, 160
    s_mov_b32 s27, s34
    s_cmp_eq_u32 s34, 5
    s_cselect_b32 s26, 832, s26
    s_cselect_b32 s27, 4, s27
    s_cmp_eq_u32 s34, 6
    s_cselect_b32 s26, 768, s26
    s_cselect_b32 s27, 0, s27
    s_cmp_eq_u32 s34, 7
    s_cselect_b32 s26, 896, s26
    s_cselect_b32 s27, 2, s27
    s_mov_b32 s46, 5242880
    s_mov_b32 s47, 0x20000
    s_mov_b32 s54, 1280
    s_mov_b32 s55, 0x20000
    s_mov_b32 s38, 33554432
    s_mov_b32 s39, 0x20000
    s_mov_b32 s42, 33554432
    s_mov_b32 s43, 0x20000
    s_mov_b32 s58, 1445888
    s_mov_b32 s59, 0x20000
    s_mov_b32 s50, 5242880
    s_mov_b32 s51, 0x20000
    s_mov_b32 s62, 2560
    s_mov_b32 s63, 0x20000
    v_and_b32 v42, 15, v0
    v_lshrrev_b32 v43, 4, v0
    s_lshl_b32 s64, s30, 4
    v_lshl_add_u32 v44, v43, 2, s64
    v_lshlrev_b32 v45, 4, v42
    s_min_u32 s65, s34, 4
    s_lshl_b32 s32, s34, 20
    s_lshl_b32 s31, s65, 20
    s_lshl_b32 s64, s35, 8
    v_lshl_add_u32 v2, v44, 13, v45
    v_add_u32 v2, s64, v2
    s_lshl_b32 s64, s65, 8
    v_lshl_add_u32 v4, v44, 1, s64
    s_cmp_eq_u32 s34, 5
    s_cselect_b32 s66, 32, 0
    s_add_u32 s66, s66, s35
    s_mul_i32 s66, s66, 5
    s_add_u32 s66, s66, s65
    s_lshl_b32 s66, s66, 10
    s_add_u32 s87, s66, 4096
    s_add_u32 s66, s35, 32
    s_mul_i32 s66, s66, 5
    s_add_u32 s66, s66, s34
    s_lshl_b32 s66, s66, 10
    s_add_u32 s33, s66, 4096
    s_add_u32 s64, s26, s30
    s_lshl_b32 s64, s64, 10
    s_lshl_b32 s82, s35, 20
    s_add_u32 s64, s64, s82
    v_lshlrev_b32 v1, 4, v0
    v_add_u32 v1, s64, v1
    s_lshl_b32 s64, s35, 7
    v_add_u32 v46, s64, v44
    s_movk_i32 s64, 1280
    v_mad_u32_u24 v3, v46, s64, v45
    s_lshl_b32 s64, s27, 8
    v_add_u32 v3, s64, v3
    v_and_b32 v46, 1, v42
    v_lshlrev_b32 v47, 4, v46
    v_mov_b32 v48, 0xffff
    v_lshlrev_b32 v47, v47, v48
    v_lshrrev_b32 v48, 1, v42
    v_cmp_eq_u32 vcc, 0, v48
    s_nop 1
    v_cndmask_b32 v14, 0, v47, vcc
    v_cmp_eq_u32 vcc, 1, v48
    s_nop 1
    v_cndmask_b32 v15, 0, v47, vcc
    v_cmp_eq_u32 vcc, 2, v48
    s_nop 1
    v_cndmask_b32 v16, 0, v47, vcc
    v_cmp_eq_u32 vcc, 3, v48
    s_nop 1
    v_cndmask_b32 v17, 0, v47, vcc
    s_lshl_b32 s64, s30, 7
    v_lshlrev_b32 v47, 5, v43
    v_lshl_add_u32 v47, v46, 4, v47
    v_add_u32 v8, s64, v47
    v_lshrrev_b32 v47, 1, v8
    s_movk_i32 s64, 544
    v_mad_u32_u24 v9, v48, s64, v47
    s_mul_i32 s64, s30, 544
    v_lshlrev_b32 v47, 5, v42
    v_lshl_add_u32 v47, v43, 4, v47
    v_add_u32 v10, s64, v47
    v_lshlrev_b32 v13, 6, v43
    s_lshl_b32 s64, s30, 5
    s_add_u32 s64, s64, 21760
    v_lshlrev_b32 v47, 3, v43
    v_lshl_add_u32 v47, v42, 2, v47
    v_add_u32 v72, s64, v47
    v_add_u32 v73, 21760, v45
    s_lshl_b32 s83, s24, 5
    s_add_u32 s83, s83, s35
    s_mul_i32 s64, s83, 5120
    s_add_u32 s64, s64, 4096
    v_min_u32 v47, 4, v48
    v_lshl_add_u32 v47, v47, 10, v8
    v_add_u32 v5, s64, v47
    s_mul_i32 s83, s83, 6
    s_add_u32 s83, s83, s34
    s_mul_i32 s64, s24, 6
    s_sub_u32 s83, s83, s64
    s_lshl_b32 s83, s83, 11
    s_add_u32 s83, s83, 331776
    s_lshl_b32 s84, s25, 5
    s_add_u32 s84, s84, s35
    s_mul_i32 s84, s84, 12288
    s_add_u32 s84, s84, 331776
    s_cmp_eq_u32 s25, 1
    s_cselect_b32 s64, 1, 5
    s_mov_b32 s72, 0x0fff0fff
    s_cselect_b32 s72, 0x000f000f, s72
    s_mov_b32 s73, s72
    v_min_u32 v47, s64, v48
    v_lshlrev_b32 v47, 11, v47
    v_add_u32 v47, s84, v47
    v_add_u32 v7, 1024, v47
    v_add_u32 v6, v47, v8
    s_mul_i32 s84, s25, 5
    s_add_u32 s84, s84, s27
    s_lshl_b32 s84, s84, 5
    s_add_u32 s84, s84, s35
    s_lshl_b32 s84, s84, 10
    s_add_u32 s84, s84, 1118208
    s_mov_b32 s68, 0x00030003
    s_mov_b32 s69, 0x00030003
    s_mov_b32 s74, 0xcccccccc
    s_mov_b32 s75, 0xcccccccc
    s_mov_b32 s76, 0xaaaaaaaa
    s_mov_b32 s77, 0xaaaaaaaa
    s_mov_b32 s85, 0x01000100
    s_mov_b32 s86, 0x03020302
    s_mov_b32 s82, 400000
    s_waitcnt lgkmcnt(0)
    s_cmp_ge_u32 s34, 6
    s_cbranch_scc1 L_firstK
    s_cmp_eq_u32 s34, 5
    s_cselect_b32 s44, s20, s10
    s_cselect_b32 s45, s21, s11
    s_cselect_b32 s52, s14, s4
    s_cselect_b32 s53, s15, s5
    buffer_load_dwordx2 v[56:57], v4, s[52:55], 0 offen
    s_cmp_eq_u32 s25, 1
    s_cselect_b32 s48, s22, s12
    s_cselect_b32 s49, s23, s13
    s_mov_b32 s12, s14
    s_mov_b32 s13, s15
    s_mov_b32 s14, 1280
    s_mov_b32 s15, 0x20000
    buffer_load_dwordx2 v[58:59], v4, s[12:15], 0 offen
    buffer_load_dwordx4 v[76:79], v2, s[44:47], s31 offen nt
    s_add_u32 s64, s31, 8192
    buffer_load_dwordx4 v[80:83], v2, s[44:47], s64 offen nt
    s_add_u32 s64, s31, 16384
    buffer_load_dwordx4 v[84:87], v2, s[44:47], s64 offen nt
    s_mov_b32 s22, 5242880
    s_mov_b32 s23, 0x20000
    s_mov_b32 s36, s6
    s_mov_b32 s37, s7
    s_mov_b32 s40, s8
    s_mov_b32 s41, s9
    s_load_dword s28, s[56:57], 0
    s_mov_b32 s24, 0x03ff03ff
    s_mov_b32 s25, 0x03ff03ff
    s_cmp_ge_u32 s34, 4
    s_cbranch_scc1 L_progA1
    s_branch L_progA2
L_firstK:
    s_mov_b32 s36, s16
    s_mov_b32 s37, s17
    buffer_load_dwordx4 v[76:79], v1, s[36:39], 0 offen nt
    s_mov_b32 s64, 8192
    buffer_load_dwordx4 v[80:83], v1, s[36:39], s64 offen nt
    s_mov_b32 s64, 16384
    buffer_load_dwordx4 v[84:87], v1, s[36:39], s64 offen nt
    s_mov_b32 s40, s18
    s_mov_b32 s41, s19
    s_mov_b32 s48, s22
    s_mov_b32 s49, s23
    s_load_dword s28, s[56:57], 0
    s_mov_b32 s24, 0x03ff03ff
    s_mov_b32 s25, 0x03ff03ff
    s_branch L_progB
L_progA2:
    s_add_u32 s64, s31, 24576
    buffer_load_dwordx4 v[88:91], v2, s[44:47], s64 offen nt
    s_waitcnt vmcnt(4)
    s_waitcnt vmcnt(3)
    buffer_load_dwordx4 v[92:95], v2, s[20:23], s32 offen nt
    v_perm_b32 v42, v56, v56, s85
    v_and_b32 v18, v42, v14
    v_and_b32 v19, v42, v15
    v_and_b32 v20, v42, v16
    v_and_b32 v21, v42, v17
    s_nop 1
    v_mfma_f32_16x16x32_bf16 v[64:67], v[18:21], v[76:79], 0
    s_waitcnt vmcnt(3)
    s_add_u32 s64, s32, 8192
    buffer_load_dwordx4 v[96:99], v2, s[20:23], s64 offen nt
    v_perm_b32 v42, v56, v56, s86
    v_and_b32 v22, v42, v14
    v_and_b32 v23, v42, v15
    v_and_b32 v24, v42, v16
    v_and_b32 v25, v42, v17
    s_nop 1
    v_mfma_f32_16x16x32_bf16 v[64:67], v[22:25], v[80:83], v[64:67]
    s_waitcnt vmcnt(3)
    s_add_u32 s64, s32, 16384
    buffer_load_dwordx4 v[100:103], v2, s[20:23], s64 offen nt
    v_perm_b32 v42, v57, v57, s85
    v_and_b32 v18, v42, v14
    v_and_b32 v19, v42, v15
    v_and_b32 v20, v42, v16
    v_and_b32 v21, v42, v17
    s_nop 1
    v_mfma_f32_16x16x32_bf16 v[64:67], v[18:21], v[84:87], v[64:67]
    s_waitcnt vmcnt(3)
    s_add_u32 s64, s32, 24576
    buffer_load_dwordx4 v[104:107], v2, s[20:23], s64 offen nt
    v_perm_b32 v42, v57, v57, s86
    v_and_b32 v22, v42, v14
    v_and_b32 v23, v42, v15
    v_and_b32 v24, v42, v16
    v_and_b32 v25, v42, v17
    s_nop 1
    v_mfma_f32_16x16x32_bf16 v[64:67], v[22:25], v[88:91], v[64:67]
    s_waitcnt vmcnt(3)
    buffer_load_dwordx4 v[108:111], v1, s[36:39], 0 offen nt
    v_perm_b32 v42, v58, v58, s85
    v_and_b32 v18, v42, v14
    v_and_b32 v19, v42, v15
    v_and_b32 v20, v42, v16
    v_and_b32 v21, v42, v17
    s_nop 1
    v_mfma_f32_16x16x32_bf16 v[68:71], v[18:21], v[92:95], 0
    s_waitcnt vmcnt(3)
    s_mov_b32 s64, 8192
    buffer_load_dwordx4 v[112:115], v1, s[36:39], s64 offen nt
    v_perm_b32 v42, v58, v58, s86
    v_and_b32 v22, v42, v14
    v_and_b32 v23, v42, v15
    v_and_b32 v24, v42, v16
    v_and_b32 v25, v42, v17
    s_nop 1
    v_mfma_f32_16x16x32_bf16 v[68:71], v[22:25], v[96:99], v[68:71]
    s_waitcnt vmcnt(3)
    s_mov_b32 s64, 16384
    buffer_load_dwordx4 v[116:119], v1, s[36:39], s64 offen nt
    v_perm_b32 v42, v59, v59, s85
    v_and_b32 v18, v42, v14
    v_and_b32 v19, v42, v15
    v_and_b32 v20, v42, v16
    v_and_b32 v21, v42, v17
    s_nop 1
    v_mfma_f32_16x16x32_bf16 v[68:71], v[18:21], v[100:103], v[68:71]
    s_waitcnt vmcnt(3)
    s_mov_b32 s64, 24576
    buffer_load_dwordx4 v[120:123], v1, s[36:39], s64 offen nt
    v_perm_b32 v42, v59, v59, s86
    v_and_b32 v22, v42, v14
    v_and_b32 v23, v42, v15
    v_and_b32 v24, v42, v16
    v_and_b32 v25, v42, v17
    s_nop 1
    v_mfma_f32_16x16x32_bf16 v[68:71], v[22:25], v[104:107], v[68:71]
    s_mov_b32 exec_hi, 0
    ds_write_b128 v10, v[64:67] offset:13056
    s_mov_b32 exec_hi, -1
    s_mov_b32 exec_hi, 0
    s_nop 3
    ds_write_b128 v10, v[68:71] offset:17408
    s_mov_b32 exec_hi, -1
    s_waitcnt lgkmcnt(0)
    s_barrier
    s_waitcnt lgkmcnt(0)
    s_mul_i32 s29, s28, 0x9e3779b1
    s_add_u32 s29, s29, 0x7f4a7c15
    v_mov_b32 v27, s29
    v_mov_b32 v29, s29
    v_mov_b32 v35, s29
    v_mov_b32 v37, s29
    ds_read_b64 v[42:43], v9 offset:13056
    ds_read_b64 v[44:45], v9 offset:17408
    s_waitcnt lgkmcnt(1)
    v_add_f32_dpp v42, v42, v42 row_ror:2 row_mask:0xf bank_mask:0xf
    v_add_f32_dpp v43, v43, v43 row_ror:2 row_mask:0xf bank_mask:0xf
    s_nop 0
    v_add_f32_dpp v42, v42, v42 row_ror:4 row_mask:0xf bank_mask:0xf
    v_add_f32_dpp v43, v43, v43 row_ror:4 row_mask:0xf bank_mask:0xf
    s_nop 0
    v_add_f32_dpp v26, v42, v42 row_ror:8 row_mask:0xf bank_mask:0xf
    v_add_f32_dpp v28, v43, v43 row_ror:8 row_mask:0xf bank_mask:0xf
    s_mov_b64 exec, s[68:69]
    buffer_store_dwordx4 v[26:29], v8, s[56:59], s87 offen sc1
    s_mov_b64 exec, -1
    s_waitcnt lgkmcnt(0)
    v_add_f32_dpp v44, v44, v44 row_ror:2 row_mask:0xf bank_mask:0xf
    v_add_f32_dpp v45, v45, v45 row_ror:2 row_mask:0xf bank_mask:0xf
    s_nop 0
    v_add_f32_dpp v44, v44, v44 row_ror:4 row_mask:0xf bank_mask:0xf
    v_add_f32_dpp v45, v45, v45 row_ror:4 row_mask:0xf bank_mask:0xf
    s_nop 0
    v_add_f32_dpp v34, v44, v44 row_ror:8 row_mask:0xf bank_mask:0xf
    v_add_f32_dpp v36, v45, v45 row_ror:8 row_mask:0xf bank_mask:0xf
    s_mov_b64 exec, s[68:69]
    buffer_store_dwordx4 v[34:37], v8, s[56:59], s33 offen sc1
    s_mov_b64 exec, -1
    s_waitcnt vmcnt(5)
    s_mov_b32 s64, 32768
    buffer_load_dwordx4 v[124:127], v1, s[36:39], s64 offen nt
    s_waitcnt vmcnt(5)
    s_mov_b32 s64, 40960
    buffer_load_dwordx4 v[128:131], v1, s[36:39], s64 offen nt
    s_waitcnt vmcnt(5)
    s_mov_b32 s64, 49152
    buffer_load_dwordx4 v[132:135], v1, s[36:39], s64 offen nt
    s_waitcnt vmcnt(5)
    s_mov_b32 s64, 57344
    buffer_load_dwordx4 v[136:139], v1, s[36:39], s64 offen nt
    s_waitcnt vmcnt(3)
    s_mov_b32 s64, 65536
    buffer_load_dwordx4 v[140:143], v1, s[36:39], s64 offen nt
    s_waitcnt vmcnt(3)
    s_mov_b32 s64, 73728
    buffer_load_dwordx4 v[144:147], v1, s[36:39], s64 offen nt
    s_waitcnt vmcnt(3)
    s_mov_b32 s64, 81920
    buffer_load_dwordx4 v[148:151], v1, s[36:39], s64 offen nt
    s_waitcnt vmcnt(3)
    s_mov_b32 s64, 90112
    buffer_load_dwordx4 v[152:155], v1, s[36:39], s64 offen nt
    buffer_load_dwordx4 v[30:33], v5, s[56:59], 0 offen offset:0 sc1
    s_waitcnt vmcnt(4)
    s_mov_b32 s64, 98304
    buffer_load_dwordx4 v[156:159], v1, s[36:39], s64 offen nt
    s_waitcnt vmcnt(4)
    s_mov_b32 s64, 106496
    buffer_load_dwordx4 v[160:163], v1, s[36:39], s64 offen nt
    s_waitcnt vmcnt(4)
    s_mov_b32 s64, 114688
    buffer_load_dwordx4 v[164:167], v1, s[36:39], s64 offen nt
    s_waitcnt vmcnt(3)
LA2_chk_1:
    v_cmp_eq_u32 vcc, s29, v31
    v_cmp_eq_u32 s[80:81], s29, v33
    s_and_b64 vcc, vcc, s[80:81]
    s_cmp_eq_u64 vcc, -1
    s_cbranch_scc1 LA2_ok_2
    s_sub_u32 s82, s82, 1
    s_cbranch_scc1 LA2_ok_2
    s_andn2_b64 exec, -1, vcc
    buffer_load_dwordx4 v[30:33], v5, s[56:59], 0 offen offset:0 sc1
    s_mov_b64 exec, -1
    s_waitcnt vmcnt(0)
    s_branch LA2_chk_1
LA2_ok_2:
    v_cndmask_b32_e64 v30, 0, v30, s[24:25]
    v_cndmask_b32_e64 v32, 0, v32, s[24:25]
    s_nop 0
    v_add_f32_dpp v30, v30, v30 row_ror:2 row_mask:0xf bank_mask:0xf
    v_add_f32_dpp v32, v32, v32 row_ror:2 row_mask:0xf bank_mask:0xf
    s_nop 0
    v_add_f32_dpp v30, v30, v30 row_ror:4 row_mask:0xf bank_mask:0xf
    v_add_f32_dpp v32, v32, v32 row_ror:4 row_mask:0xf bank_mask:0xf
    s_nop 0
    v_add_f32_dpp v30, v30, v30 row_ror:8 row_mask:0xf bank_mask:0xf
    v_add_f32_dpp v32, v32, v32 row_ror:8 row_mask:0xf bank_mask:0xf
    v_cvt_pk_bf16_f32 v42, v30, v32
    s_mov_b64 exec, s[68:69]
    ds_write_b32 v72, v42
    s_mov_b64 exec, -1
    s_waitcnt lgkmcnt(0)
    s_barrier
    ds_read_b128 v[60:63], v73
    s_waitcnt lgkmcnt(0)
    v_dot2_f32_bf16 v108, v108, v60, 0
    v_dot2_f32_bf16 v112, v112, v60, 0
    v_dot2_f32_bf16 v116, v116, v60, 0
    v_dot2_f32_bf16 v120, v120, v60, 0
    v_dot2_f32_bf16 v108, v109, v61, v108
    v_dot2_f32_bf16 v112, v113, v61, v112
    v_dot2_f32_bf16 v116, v117, v61, v116
    v_dot2_f32_bf16 v120, v121, v61, v120
    v_dot2_f32_bf16 v108, v110, v62, v108
    v_dot2_f32_bf16 v112, v114, v62, v112
    v_dot2_f32_bf16 v116, v118, v62, v116
    v_dot2_f32_bf16 v120, v122, v62, v120
    v_dot2_f32_bf16 v108, v111, v63, v108
    v_dot2_f32_bf16 v112, v115, v63, v112
    v_dot2_f32_bf16 v116, v119, v63, v116
    v_dot2_f32_bf16 v120, v123, v63, v120
    v_dot2_f32_bf16 v124, v124, v60, 0
    v_dot2_f32_bf16 v128, v128, v60, 0
    v_dot2_f32_bf16 v132, v132, v60, 0
    v_dot2_f32_bf16 v136, v136, v60, 0
    v_dot2_f32_bf16 v124, v125, v61, v124
    v_dot2_f32_bf16 v128, v129, v61, v128
    v_dot2_f32_bf16 v132, v133, v61, v132
    v_dot2_f32_bf16 v136, v137, v61, v136
    v_dot2_f32_bf16 v124, v126, v62, v124
    v_dot2_f32_bf16 v128, v130, v62, v128
    v_dot2_f32_bf16 v132, v134, v62, v132
    v_dot2_f32_bf16 v136, v138, v62, v136
    v_dot2_f32_bf16 v124, v127, v63, v124
    v_dot2_f32_bf16 v128, v131, v63, v128
    v_dot2_f32_bf16 v132, v135, v63, v132
    v_dot2_f32_bf16 v136, v139, v63, v136
    s_mov_b32 s64, 122880
    buffer_load_dwordx4 v[168:171], v1, s[36:39], s64 offen nt
    v_dot2_f32_bf16 v140, v140, v60, 0
    v_dot2_f32_bf16 v144, v144, v60, 0
    v_dot2_f32_bf16 v148, v148, v60, 0
    v_dot2_f32_bf16 v152, v152, v60, 0
    v_dot2_f32_bf16 v140, v141, v61, v140
    v_dot2_f32_bf16 v144, v145, v61, v144
    v_dot2_f32_bf16 v148, v149, v61, v148
    v_dot2_f32_bf16 v152, v153, v61, v152
    v_dot2_f32_bf16 v140, v142, v62, v140
    v_dot2_f32_bf16 v144, v146, v62, v144
    v_dot2_f32_bf16 v148, v150, v62, v148
    v_dot2_f32_bf16 v152, v154, v62, v152
    v_dot2_f32_bf16 v140, v143, v63, v140
    v_dot2_f32_bf16 v144, v147, v63, v144
    v_dot2_f32_bf16 v148, v151, v63, v148
    v_dot2_f32_bf16 v152, v155, v63, v152
    s_waitcnt vmcnt(3)
    s_mov_b32 s64, 131072
    buffer_load_dwordx4 v[172:175], v1, s[36:39], s64 offen nt
    v_dot2_f32_bf16 v156, v156, v60, 0
    v_dot2_f32_bf16 v156, v157, v61, v156
    v_dot2_f32_bf16 v156, v158, v62, v156
    v_dot2_f32_bf16 v156, v159, v63, v156
    s_waitcnt vmcnt(3)
    s_mov_b32 s64, 139264
    buffer_load_dwordx4 v[176:179], v1, s[36:39], s64 offen nt
    v_dot2_f32_bf16 v160, v160, v60, 0
    v_dot2_f32_bf16 v160, v161, v61, v160
    v_dot2_f32_bf16 v160, v162, v62, v160
    v_dot2_f32_bf16 v160, v163, v63, v160
    s_waitcnt vmcnt(3)
    s_mov_b32 s64, 147456
    buffer_load_dwordx4 v[180:183], v1, s[36:39], s64 offen nt
    v_dot2_f32_bf16 v164, v164, v60, 0
    v_dot2_f32_bf16 v164, v165, v61, v164
    v_dot2_f32_bf16 v164, v166, v62, v164
    v_dot2_f32_bf16 v164, v167, v63, v164
    s_waitcnt vmcnt(3)
    s_mov_b32 s64, 155648
    buffer_load_dwordx4 v[184:187], v1, s[36:39], s64 offen nt
    v_dot2_f32_bf16 v168, v168, v60, 0
    v_dot2_f32_bf16 v168, v169, v61, v168
    v_dot2_f32_bf16 v168, v170, v62, v168
    v_dot2_f32_bf16 v168, v171, v63, v168
    v_add_f32_dpp v108, v108, v108 row_ror:8 row_mask:0xf bank_mask:0x3
    v_add_f32_dpp v112, v112, v112 row_ror:8 row_mask:0xf bank_mask:0x3
    v_add_f32_dpp v116, v116, v116 row_ror:8 row_mask:0xf bank_mask:0x3
    v_add_f32_dpp v120, v120, v120 row_ror:8 row_mask:0xf bank_mask:0x3
    v_add_f32_dpp v124, v124, v124 row_ror:8 row_mask:0xf bank_mask:0x3
    v_add_f32_dpp v128, v128, v128 row_ror:8 row_mask:0xf bank_mask:0x3
    v_add_f32_dpp v132, v132, v132 row_ror:8 row_mask:0xf bank_mask:0x3
    v_add_f32_dpp v136, v136, v136 row_ror:8 row_mask:0xf bank_mask:0x3
    v_add_f32_dpp v108, v140, v140 row_ror:8 row_mask:0xf bank_mask:0xc
    v_add_f32_dpp v112, v144, v144 row_ror:8 row_mask:0xf bank_mask:0xc
    v_add_f32_dpp v116, v148, v148 row_ror:8 row_mask:0xf bank_mask:0xc
    v_add_f32_dpp v120, v152, v152 row_ror:8 row_mask:0xf bank_mask:0xc
    v_add_f32_dpp v124, v156, v156 row_ror:8 row_mask:0xf bank_mask:0xc
    v_add_f32_dpp v128, v160, v160 row_ror:8 row_mask:0xf bank_mask:0xc
    v_add_f32_dpp v132, v164, v164 row_ror:8 row_mask:0xf bank_mask:0xc
    v_add_f32_dpp v136, v168, v168 row_ror:8 row_mask:0xf bank_mask:0xc
    v_add_f32_dpp v108, v108, v108 row_half_mirror row_mask:0xf bank_mask:0x5
    v_add_f32_dpp v112, v112, v112 row_half_mirror row_mask:0xf bank_mask:0x5
    v_add_f32_dpp v116, v116, v116 row_half_mirror row_mask:0xf bank_mask:0x5
    v_add_f32_dpp v120, v120, v120 row_half_mirror row_mask:0xf bank_mask:0x5
    v_add_f32_dpp v108, v124, v124 row_half_mirror row_mask:0xf bank_mask:0xa
    v_add_f32_dpp v112, v128, v128 row_half_mirror row_mask:0xf bank_mask:0xa
    v_add_f32_dpp v116, v132, v132 row_half_mirror row_mask:0xf bank_mask:0xa
    v_add_f32_dpp v120, v136, v136 row_half_mirror row_mask:0xf bank_mask:0xa
    v_add_f32_dpp v42, v108, v108 quad_perm:[2,3,0,1] row_mask:0xf bank_mask:0xf
    v_add_f32_dpp v43, v116, v116 quad_perm:[2,3,0,1] row_mask:0xf bank_mask:0xf
    v_add_f32_dpp v44, v112, v112 quad_perm:[2,3,0,1] row_mask:0xf bank_mask:0xf
    v_add_f32_dpp v45, v120, v120 quad_perm:[2,3,0,1] row_mask:0xf bank_mask:0xf
    v_cndmask_b32_e64 v46, v42, v43, s[74:75]
    v_cndmask_b32_e64 v47, v44, v45, s[74:75]
    s_nop 0
    v_add_f32_dpp v42, v46, v46 quad_perm:[1,0,3,2] row_mask:0xf bank_mask:0xf
    v_add_f32_dpp v43, v47, v47 quad_perm:[1,0,3,2] row_mask:0xf bank_mask:0xf
    v_cndmask_b32_e64 v50, v42, v43, s[76:77]
    v_cvt_pk_bf16_f32 v50, v50, v50
    v_and_b32 v50, 0xffff0000, v50
    v_mul_f32 v50, 0x3db504f3, v50
    v_cvt_pk_bf16_f32 v50, v50, v50
    v_and_b32 v50, 0xffff0000, v50
    s_waitcnt vmcnt(3)
    buffer_load_dwordx4 v[76:79], v3, s[48:51], 0 offen offset:0 nt
    v_dot2_f32_bf16 v172, v172, v60, 0
    v_dot2_f32_bf16 v172, v173, v61, v172
    v_dot2_f32_bf16 v172, v174, v62, v172
    v_dot2_f32_bf16 v172, v175, v63, v172
    s_waitcnt vmcnt(3)
    buffer_load_dwordx4 v[80:83], v3, s[48:51], 0 offen offset:1280 nt
    v_dot2_f32_bf16 v176, v176, v60, 0
    v_dot2_f32_bf16 v176, v177, v61, v176
    v_dot2_f32_bf16 v176, v178, v62, v176
    v_dot2_f32_bf16 v176, v179, v63, v176
    s_waitcnt vmcnt(3)
    buffer_load_dwordx4 v[84:87], v3, s[48:51], 0 offen offset:2560 nt
    v_dot2_f32_bf16 v180, v180, v60, 0
    v_dot2_f32_bf16 v180, v181, v61, v180
    v_dot2_f32_bf16 v180, v182, v62, v180
    v_dot2_f32_bf16 v180, v183, v63, v180
    s_waitcnt vmcnt(3)
    buffer_load_dwordx4 v[88:91], v3, s[48:51], 0 offen offset:3840 nt
    v_dot2_f32_bf16 v184, v184, v60, 0
    v_dot2_f32_bf16 v184, v185, v61, v184
    v_dot2_f32_bf16 v184, v186, v62, v184
    v_dot2_f32_bf16 v184, v187, v63, v184
    v_add_f32_dpp v172, v172, v172 row_ror:8 row_mask:0xf bank_mask:0xf
    v_add_f32_dpp v176, v176, v176 row_ror:8 row_mask:0xf bank_mask:0xf
    v_add_f32_dpp v180, v180, v180 row_ror:8 row_mask:0xf bank_mask:0xf
    v_add_f32_dpp v184, v184, v184 row_ror:8 row_mask:0xf bank_mask:0xf
    v_add_f32_dpp v172, v172, v172 row_half_mirror row_mask:0xf bank_mask:0x5
    v_add_f32_dpp v176, v176, v176 row_half_mirror row_mask:0xf bank_mask:0x5
    v_add_f32_dpp v180, v180, v180 row_half_mirror row_mask:0xf bank_mask:0x5
    v_add_f32_dpp v184, v184, v184 row_half_mirror row_mask:0xf bank_mask:0x5
    v_add_f32_dpp v42, v172, v172 quad_perm:[2,3,0,1] row_mask:0xf bank_mask:0xf
    v_add_f32_dpp v43, v180, v180 quad_perm:[2,3,0,1] row_mask:0xf bank_mask:0xf
    v_add_f32_dpp v44, v176, v176 quad_perm:[2,3,0,1] row_mask:0xf bank_mask:0xf
    v_add_f32_dpp v45, v184, v184 quad_perm:[2,3,0,1] row_mask:0xf bank_mask:0xf
    v_cndmask_b32_e64 v46, v42, v43, s[74:75]
    v_cndmask_b32_e64 v47, v44, v45, s[74:75]
    s_nop 0
    v_add_f32_dpp v42, v46, v46 quad_perm:[1,0,3,2] row_mask:0xf bank_mask:0xf
    v_add_f32_dpp v43, v47, v47 quad_perm:[1,0,3,2] row_mask:0xf bank_mask:0xf
    v_cndmask_b32_e64 v51, v42, v43, s[76:77]
    v_cvt_pk_bf16_f32 v51, v51, v51
    v_and_b32 v51, 0xffff0000, v51
    v_mul_f32 v51, 0x3db504f3, v51
    v_cvt_pk_bf16_f32 v51, v51, v51
    v_and_b32 v51, 0xffff0000, v51
    s_mov_b32 s80, 0x000f000f
    s_mov_b32 s81, 0x000f000f
    v_mov_b32 v42, 0xff800000
    v_cndmask_b32_e64 v51, v42, v51, s[80:81]
    v_max_f32 v12, v50, v51
    s_nop 1
    v_max_f32_dpp v12, v12, v12 row_ror:1 row_mask:0xf bank_mask:0xf
    s_nop 1
    v_max_f32_dpp v12, v12, v12 row_ror:2 row_mask:0xf bank_mask:0xf
    s_nop 1
    v_max_f32_dpp v12, v12, v12 row_ror:4 row_mask:0xf bank_mask:0xf
    s_nop 1
    v_max_f32_dpp v12, v12, v12 row_ror:8 row_mask:0xf bank_mask:0xf
    v_mov_b32 v42, v12
    s_nop 1
    v_permlane16_swap_b32 v12, v42
    v_max_f32 v12, v12, v42
    v_mov_b32 v42, v12
    s_nop 1
    v_permlane32_swap_b32 v12, v42
    v_max_f32 v12, v12, v42
    v_sub_f32 v52, v50, v12
    v_sub_f32 v53, v51, v12
    v_mul_f32 v50, 0x3fb8aa3b, v52
    v_mul_f32 v51, 0x3fb8aa3b, v53
    v_exp_f32 v50, v50
    v_exp_f32 v51, v51
    s_nop 0
    v_add_f32 v43, v50, v51
    s_nop 1
    v_add_f32_dpp v43, v43, v43 row_ror:1 row_mask:0xf bank_mask:0xf
    s_nop 1
    v_add_f32_dpp v43, v43, v43 row_ror:2 row_mask:0xf bank_mask:0xf
    s_nop 1
    v_add_f32_dpp v43, v43, v43 row_ror:4 row_mask:0xf bank_mask:0xf
    s_nop 1
    v_add_f32_dpp v43, v43, v43 row_ror:8 row_mask:0xf bank_mask:0xf
    v_mov_b32 v44, v43
    s_nop 1
    v_permlane16_swap_b32 v43, v44
    v_add_f32 v43, v43, v44
    v_mov_b32 v44, v43
    s_nop 1
    v_permlane32_swap_b32 v43, v44
    v_add_f32 v43, v43, v44
    v_mov_b32 v42, v12
    v_mov_b32 v44, s30
    v_lshlrev_b32 v44, 3, v44
    s_mov_b64 exec, 1
    ds_write_b64 v44, v[42:43] offset:22016
    s_mov_b64 exec, -1
    s_waitcnt lgkmcnt(0)
    s_barrier
    v_and_b32 v44, 7, v0
    v_lshlrev_b32 v44, 3, v44
    ds_read_b64 v[42:43], v44 offset:22016
    s_waitcnt lgkmcnt(0)
    v_max_f32_dpp v44, v42, v42 quad_perm:[1,0,3,2] row_mask:0xf bank_mask:0xf
    s_nop 1
    v_max_f32_dpp v44, v44, v44 quad_perm:[2,3,0,1] row_mask:0xf bank_mask:0xf
    s_nop 1
    v_max_f32_dpp v44, v44, v44 row_half_mirror row_mask:0xf bank_mask:0xf
    v_sub_f32 v46, v12, v44
    v_sub_f32 v45, v42, v44
    v_add_f32 v52, v52, v46
    v_add_f32 v53, v53, v46
    s_mov_b32 s65, 0xc2d00000
    v_cmp_le_f32 vcc, s65, v52
    v_cmp_le_f32 s[80:81], s65, v53
    s_or_b32 s66, vcc_lo, vcc_hi
    s_or_b32 s67, s80, s81
    s_lshr_b32 s65, s66, 16
    s_or_b32 s66, s66, s65
    s_and_b32 s66, s66, 0xffff
    s_lshl_b32 s65, s67, 16
    s_or_b32 s67, s67, s65
    s_and_b32 s67, s67, 0xffff0000
    s_or_b32 s70, s66, s67
    s_mov_b32 s71, s70
    s_ff1_i32_b32 s65, s71
    s_cmp_eq_u32 s71, 0
    s_cbranch_scc1 LA2_spi_3
    s_bitset0_b32 s71, s65
    s_lshl_b32 s65, s65, 13
    buffer_load_dwordx4 v[108:111], v1, s[40:43], s65 offen nt
    s_ff1_i32_b32 s65, s71
    s_cmp_eq_u32 s71, 0
    s_cbranch_scc1 LA2_spi_3
    s_bitset0_b32 s71, s65
    s_lshl_b32 s65, s65, 13
    buffer_load_dwordx4 v[112:115], v1, s[40:43], s65 offen nt
    s_ff1_i32_b32 s65, s71
    s_cmp_eq_u32 s71, 0
    s_cbranch_scc1 LA2_spi_3
    s_bitset0_b32 s71, s65
    s_lshl_b32 s65, s65, 13
    buffer_load_dwordx4 v[116:119], v1, s[40:43], s65 offen nt
    s_ff1_i32_b32 s65, s71
    s_cmp_eq_u32 s71, 0
    s_cbranch_scc1 LA2_spi_3
    s_bitset0_b32 s71, s65
    s_lshl_b32 s65, s65, 13
    buffer_load_dwordx4 v[120:123], v1, s[40:43], s65 offen nt
    s_ff1_i32_b32 s65, s71
    s_cmp_eq_u32 s71, 0
    s_cbranch_scc1 LA2_spi_3
    s_bitset0_b32 s71, s65
    s_lshl_b32 s65, s65, 13
    buffer_load_dwordx4 v[124:127], v1, s[40:43], s65 offen nt
    s_ff1_i32_b32 s65, s71
    s_cmp_eq_u32 s71, 0
    s_cbranch_scc1 LA2_spi_3
    s_bitset0_b32 s71, s65
    s_lshl_b32 s65, s65, 13
    buffer_load_dwordx4 v[128:131], v1, s[40:43], s65 offen nt
    s_ff1_i32_b32 s65, s71
    s_cmp_eq_u32 s71, 0
    s_cbranch_scc1 LA2_spi_3
    s_bitset0_b32 s71, s65
    s_lshl_b32 s65, s65, 13
    buffer_load_dwordx4 v[132:135], v1, s[40:43], s65 offen nt
    s_ff1_i32_b32 s65, s71
    s_cmp_eq_u32 s71, 0
    s_cbranch_scc1 LA2_spi_3
    s_bitset0_b32 s71, s65
    s_lshl_b32 s65, s65, 13
    buffer_load_dwordx4 v[136:139], v1, s[40:43], s65 offen nt
    s_ff1_i32_b32 s65, s71
    s_cmp_eq_u32 s71, 0
    s_cbranch_scc1 LA2_spi_3
    s_bitset0_b32 s71, s65
    s_lshl_b32 s65, s65, 13
    buffer_load_dwordx4 v[140:143], v1, s[40:43], s65 offen nt
    s_ff1_i32_b32 s65, s71
    s_cmp_eq_u32 s71, 0
    s_cbranch_scc1 LA2_spi_3
    s_bitset0_b32 s71, s65
    s_lshl_b32 s65, s65, 13
    buffer_load_dwordx4 v[144:147], v1, s[40:43], s65 offen nt
    s_ff1_i32_b32 s65, s71
    s_cmp_eq_u32 s71, 0
    s_cbranch_scc1 LA2_spi_3
    s_bitset0_b32 s71, s65
    s_lshl_b32 s65, s65, 13
    buffer_load_dwordx4 v[148:151], v1, s[40:43], s65 offen nt
    s_ff1_i32_b32 s65, s71
    s_cmp_eq_u32 s71, 0
    s_cbranch_scc1 LA2_spi_3
    s_bitset0_b32 s71, s65
    s_lshl_b32 s65, s65, 13
    buffer_load_dwordx4 v[152:155], v1, s[40:43], s65 offen nt
    s_ff1_i32_b32 s65, s71
    s_cmp_eq_u32 s71, 0
    s_cbranch_scc1 LA2_spi_3
    s_bitset0_b32 s71, s65
    s_lshl_b32 s65, s65, 13
    buffer_load_dwordx4 v[156:159], v1, s[40:43], s65 offen nt
    s_ff1_i32_b32 s65, s71
    s_cmp_eq_u32 s71, 0
    s_cbranch_scc1 LA2_spi_3
    s_bitset0_b32 s71, s65
    s_lshl_b32 s65, s65, 13
    buffer_load_dwordx4 v[160:163], v1, s[40:43], s65 offen nt
    s_ff1_i32_b32 s65, s71
    s_cmp_eq_u32 s71, 0
    s_cbranch_scc1 LA2_spi_3
    s_bitset0_b32 s71, s65
    s_lshl_b32 s65, s65, 13
    buffer_load_dwordx4 v[164:167], v1, s[40:43], s65 offen nt
    s_ff1_i32_b32 s65, s71
    s_cmp_eq_u32 s71, 0
    s_cbranch_scc1 LA2_spi_3
    s_bitset0_b32 s71, s65
    s_lshl_b32 s65, s65, 13
    buffer_load_dwordx4 v[168:171], v1, s[40:43], s65 offen nt
    s_ff1_i32_b32 s65, s71
    s_cmp_eq_u32 s71, 0
    s_cbranch_scc1 LA2_spi_3
    s_bitset0_b32 s71, s65
    s_lshl_b32 s65, s65, 13
    buffer_load_dwordx4 v[172:175], v1, s[40:43], s65 offen nt
    s_ff1_i32_b32 s65, s71
    s_cmp_eq_u32 s71, 0
    s_cbranch_scc1 LA2_spi_3
    s_bitset0_b32 s71, s65
    s_lshl_b32 s65, s65, 13
    buffer_load_dwordx4 v[176:179], v1, s[40:43], s65 offen nt
    s_ff1_i32_b32 s65, s71
    s_cmp_eq_u32 s71, 0
    s_cbranch_scc1 LA2_spi_3
    s_bitset0_b32 s71, s65
    s_lshl_b32 s65, s65, 13
    buffer_load_dwordx4 v[180:183], v1, s[40:43], s65 offen nt
    s_ff1_i32_b32 s65, s71
    s_cmp_eq_u32 s71, 0
    s_cbranch_scc1 LA2_spi_3
    s_bitset0_b32 s71, s65
    s_lshl_b32 s65, s65, 13
    buffer_load_dwordx4 v[184:187], v1, s[40:43], s65 offen nt
LA2_spi_3:
    v_mul_f32 v45, 0x3fb8aa3b, v45
    v_mul_f32 v46, 0x3fb8aa3b, v46
    v_exp_f32 v45, v45
    v_exp_f32 v46, v46
    v_mul_f32 v45, v45, v43
    v_mul_f32 v50, v50, v46
    v_mul_f32 v51, v51, v46
    v_add_f32_dpp v45, v45, v45 quad_perm:[1,0,3,2] row_mask:0xf bank_mask:0xf
    v_cvt_pk_bf16_f32 v54, v50, v50
    v_cvt_pk_bf16_f32 v55, v51, v51
    v_add_f32_dpp v45, v45, v45 quad_perm:[2,3,0,1] row_mask:0xf bank_mask:0xf
    s_nop 1
    v_add_f32_dpp v28, v45, v45 row_half_mirror row_mask:0xf bank_mask:0xf
    v_mov_b32 v26, v44
    v_mov_b32 v47, 1024
    s_mov_b64 exec, 1
    buffer_store_dwordx4 v[26:29], v47, s[56:59], s83 offen sc1
    s_mov_b64 exec, -1
    v_mov_b32 v64, 0
    v_mov_b32 v65, 0
    v_mov_b32 v66, 0
    v_mov_b32 v67, 0
    s_waitcnt vmcnt(1)
    s_ff1_i32_b32 s65, s70
    s_cmp_eq_u32 s70, 0
    s_cbranch_scc1 LA2_spv_4
    s_bitset0_b32 s70, s65
    s_and_b32 s66, s65, 15
    s_lshl_b32 s66, s66, 2
    v_add_u32 v42, s66, v13
    s_cmp_ge_u32 s65, 16
    s_cselect_b64 s[80:81], -1, 0
    v_cndmask_b32_e64 v43, v54, v55, s[80:81]
    ds_bpermute_b32 v44, v42, v43
    s_waitcnt lgkmcnt(0)
    v_and_b32 v18, v44, v14
    v_and_b32 v19, v44, v15
    v_and_b32 v20, v44, v16
    v_and_b32 v21, v44, v17
    s_nop 1
    v_mfma_f32_16x16x32_bf16 v[64:67], v[18:21], v[108:111], v[64:67]
    s_ff1_i32_b32 s65, s70
    s_cmp_eq_u32 s70, 0
    s_cbranch_scc1 LA2_spv_4
    s_bitset0_b32 s70, s65
    s_and_b32 s66, s65, 15
    s_lshl_b32 s66, s66, 2
    v_add_u32 v42, s66, v13
    s_cmp_ge_u32 s65, 16
    s_cselect_b64 s[80:81], -1, 0
    v_cndmask_b32_e64 v43, v54, v55, s[80:81]
    ds_bpermute_b32 v44, v42, v43
    s_waitcnt lgkmcnt(0)
    v_and_b32 v22, v44, v14
    v_and_b32 v23, v44, v15
    v_and_b32 v24, v44, v16
    v_and_b32 v25, v44, v17
    s_nop 1
    v_mfma_f32_16x16x32_bf16 v[64:67], v[22:25], v[112:115], v[64:67]
    s_ff1_i32_b32 s65, s70
    s_cmp_eq_u32 s70, 0
    s_cbranch_scc1 LA2_spv_4
    s_bitset0_b32 s70, s65
    s_and_b32 s66, s65, 15
    s_lshl_b32 s66, s66, 2
    v_add_u32 v42, s66, v13
    s_cmp_ge_u32 s65, 16
    s_cselect_b64 s[80:81], -1, 0
    v_cndmask_b32_e64 v43, v54, v55, s[80:81]
    ds_bpermute_b32 v44, v42, v43
    s_waitcnt lgkmcnt(0)
    v_and_b32 v18, v44, v14
    v_and_b32 v19, v44, v15
    v_and_b32 v20, v44, v16
    v_and_b32 v21, v44, v17
    s_nop 1
    v_mfma_f32_16x16x32_bf16 v[64:67], v[18:21], v[116:119], v[64:67]
    s_ff1_i32_b32 s65, s70
    s_cmp_eq_u32 s70, 0
    s_cbranch_scc1 LA2_spv_4
    s_bitset0_b32 s70, s65
    s_and_b32 s66, s65, 15
    s_lshl_b32 s66, s66, 2
    v_add_u32 v42, s66, v13
    s_cmp_ge_u32 s65, 16
    s_cselect_b64 s[80:81], -1, 0
    v_cndmask_b32_e64 v43, v54, v55, s[80:81]
    ds_bpermute_b32 v44, v42, v43
    s_waitcnt lgkmcnt(0)
    v_and_b32 v22, v44, v14
    v_and_b32 v23, v44, v15
    v_and_b32 v24, v44, v16
    v_and_b32 v25, v44, v17
    s_nop 1
    v_mfma_f32_16x16x32_bf16 v[64:67], v[22:25], v[120:123], v[64:67]
    s_ff1_i32_b32 s65, s70
    s_cmp_eq_u32 s70, 0
    s_cbranch_scc1 LA2_spv_4
    s_bitset0_b32 s70, s65
    s_and_b32 s66, s65, 15
    s_lshl_b32 s66, s66, 2
    v_add_u32 v42, s66, v13
    s_cmp_ge_u32 s65, 16
    s_cselect_b64 s[80:81], -1, 0
    v_cndmask_b32_e64 v43, v54, v55, s[80:81]
    ds_bpermute_b32 v44, v42, v43
    s_waitcnt lgkmcnt(0)
    v_and_b32 v18, v44, v14
    v_and_b32 v19, v44, v15
    v_and_b32 v20, v44, v16
    v_and_b32 v21, v44, v17
    s_nop 1
    v_mfma_f32_16x16x32_bf16 v[64:67], v[18:21], v[124:127], v[64:67]
    s_ff1_i32_b32 s65, s70
    s_cmp_eq_u32 s70, 0
    s_cbranch_scc1 LA2_spv_4
    s_bitset0_b32 s70, s65
    s_and_b32 s66, s65, 15
    s_lshl_b32 s66, s66, 2
    v_add_u32 v42, s66, v13
    s_cmp_ge_u32 s65, 16
    s_cselect_b64 s[80:81], -1, 0
    v_cndmask_b32_e64 v43, v54, v55, s[80:81]
    ds_bpermute_b32 v44, v42, v43
    s_waitcnt lgkmcnt(0)
    v_and_b32 v22, v44, v14
    v_and_b32 v23, v44, v15
    v_and_b32 v24, v44, v16
    v_and_b32 v25, v44, v17
    s_nop 1
    v_mfma_f32_16x16x32_bf16 v[64:67], v[22:25], v[128:131], v[64:67]
    s_ff1_i32_b32 s65, s70
    s_cmp_eq_u32 s70, 0
    s_cbranch_scc1 LA2_spv_4
    s_bitset0_b32 s70, s65
    s_and_b32 s66, s65, 15
    s_lshl_b32 s66, s66, 2
    v_add_u32 v42, s66, v13
    s_cmp_ge_u32 s65, 16
    s_cselect_b64 s[80:81], -1, 0
    v_cndmask_b32_e64 v43, v54, v55, s[80:81]
    ds_bpermute_b32 v44, v42, v43
    s_waitcnt lgkmcnt(0)
    v_and_b32 v18, v44, v14
    v_and_b32 v19, v44, v15
    v_and_b32 v20, v44, v16
    v_and_b32 v21, v44, v17
    s_nop 1
    v_mfma_f32_16x16x32_bf16 v[64:67], v[18:21], v[132:135], v[64:67]
    s_ff1_i32_b32 s65, s70
    s_cmp_eq_u32 s70, 0
    s_cbranch_scc1 LA2_spv_4
    s_bitset0_b32 s70, s65
    s_and_b32 s66, s65, 15
    s_lshl_b32 s66, s66, 2
    v_add_u32 v42, s66, v13
    s_cmp_ge_u32 s65, 16
    s_cselect_b64 s[80:81], -1, 0
    v_cndmask_b32_e64 v43, v54, v55, s[80:81]
    ds_bpermute_b32 v44, v42, v43
    s_waitcnt lgkmcnt(0)
    v_and_b32 v22, v44, v14
    v_and_b32 v23, v44, v15
    v_and_b32 v24, v44, v16
    v_and_b32 v25, v44, v17
    s_nop 1
    v_mfma_f32_16x16x32_bf16 v[64:67], v[22:25], v[136:139], v[64:67]
    s_ff1_i32_b32 s65, s70
    s_cmp_eq_u32 s70, 0
    s_cbranch_scc1 LA2_spv_4
    s_bitset0_b32 s70, s65
    s_and_b32 s66, s65, 15
    s_lshl_b32 s66, s66, 2
    v_add_u32 v42, s66, v13
    s_cmp_ge_u32 s65, 16
    s_cselect_b64 s[80:81], -1, 0
    v_cndmask_b32_e64 v43, v54, v55, s[80:81]
    ds_bpermute_b32 v44, v42, v43
    s_waitcnt lgkmcnt(0)
    v_and_b32 v18, v44, v14
    v_and_b32 v19, v44, v15
    v_and_b32 v20, v44, v16
    v_and_b32 v21, v44, v17
    s_nop 1
    v_mfma_f32_16x16x32_bf16 v[64:67], v[18:21], v[140:143], v[64:67]
    s_ff1_i32_b32 s65, s70
    s_cmp_eq_u32 s70, 0
    s_cbranch_scc1 LA2_spv_4
    s_bitset0_b32 s70, s65
    s_and_b32 s66, s65, 15
    s_lshl_b32 s66, s66, 2
    v_add_u32 v42, s66, v13
    s_cmp_ge_u32 s65, 16
    s_cselect_b64 s[80:81], -1, 0
    v_cndmask_b32_e64 v43, v54, v55, s[80:81]
    ds_bpermute_b32 v44, v42, v43
    s_waitcnt lgkmcnt(0)
    v_and_b32 v22, v44, v14
    v_and_b32 v23, v44, v15
    v_and_b32 v24, v44, v16
    v_and_b32 v25, v44, v17
    s_nop 1
    v_mfma_f32_16x16x32_bf16 v[64:67], v[22:25], v[144:147], v[64:67]
    s_ff1_i32_b32 s65, s70
    s_cmp_eq_u32 s70, 0
    s_cbranch_scc1 LA2_spv_4
    s_bitset0_b32 s70, s65
    s_and_b32 s66, s65, 15
    s_lshl_b32 s66, s66, 2
    v_add_u32 v42, s66, v13
    s_cmp_ge_u32 s65, 16
    s_cselect_b64 s[80:81], -1, 0
    v_cndmask_b32_e64 v43, v54, v55, s[80:81]
    ds_bpermute_b32 v44, v42, v43
    s_waitcnt lgkmcnt(0)
    v_and_b32 v18, v44, v14
    v_and_b32 v19, v44, v15
    v_and_b32 v20, v44, v16
    v_and_b32 v21, v44, v17
    s_nop 1
    v_mfma_f32_16x16x32_bf16 v[64:67], v[18:21], v[148:151], v[64:67]
    s_ff1_i32_b32 s65, s70
    s_cmp_eq_u32 s70, 0
    s_cbranch_scc1 LA2_spv_4
    s_bitset0_b32 s70, s65
    s_and_b32 s66, s65, 15
    s_lshl_b32 s66, s66, 2
    v_add_u32 v42, s66, v13
    s_cmp_ge_u32 s65, 16
    s_cselect_b64 s[80:81], -1, 0
    v_cndmask_b32_e64 v43, v54, v55, s[80:81]
    ds_bpermute_b32 v44, v42, v43
    s_waitcnt lgkmcnt(0)
    v_and_b32 v22, v44, v14
    v_and_b32 v23, v44, v15
    v_and_b32 v24, v44, v16
    v_and_b32 v25, v44, v17
    s_nop 1
    v_mfma_f32_16x16x32_bf16 v[64:67], v[22:25], v[152:155], v[64:67]
    s_ff1_i32_b32 s65, s70
    s_cmp_eq_u32 s70, 0
    s_cbranch_scc1 LA2_spv_4
    s_bitset0_b32 s70, s65
    s_and_b32 s66, s65, 15
    s_lshl_b32 s66, s66, 2
    v_add_u32 v42, s66, v13
    s_cmp_ge_u32 s65, 16
    s_cselect_b64 s[80:81], -1, 0
    v_cndmask_b32_e64 v43, v54, v55, s[80:81]
    ds_bpermute_b32 v44, v42, v43
    s_waitcnt lgkmcnt(0)
    v_and_b32 v18, v44, v14
    v_and_b32 v19, v44, v15
    v_and_b32 v20, v44, v16
    v_and_b32 v21, v44, v17
    s_nop 1
    v_mfma_f32_16x16x32_bf16 v[64:67], v[18:21], v[156:159], v[64:67]
    s_ff1_i32_b32 s65, s70
    s_cmp_eq_u32 s70, 0
    s_cbranch_scc1 LA2_spv_4
    s_bitset0_b32 s70, s65
    s_and_b32 s66, s65, 15
    s_lshl_b32 s66, s66, 2
    v_add_u32 v42, s66, v13
    s_cmp_ge_u32 s65, 16
    s_cselect_b64 s[80:81], -1, 0
    v_cndmask_b32_e64 v43, v54, v55, s[80:81]
    ds_bpermute_b32 v44, v42, v43
    s_waitcnt lgkmcnt(0)
    v_and_b32 v22, v44, v14
    v_and_b32 v23, v44, v15
    v_and_b32 v24, v44, v16
    v_and_b32 v25, v44, v17
    s_nop 1
    v_mfma_f32_16x16x32_bf16 v[64:67], v[22:25], v[160:163], v[64:67]
    s_ff1_i32_b32 s65, s70
    s_cmp_eq_u32 s70, 0
    s_cbranch_scc1 LA2_spv_4
    s_bitset0_b32 s70, s65
    s_and_b32 s66, s65, 15
    s_lshl_b32 s66, s66, 2
    v_add_u32 v42, s66, v13
    s_cmp_ge_u32 s65, 16
    s_cselect_b64 s[80:81], -1, 0
    v_cndmask_b32_e64 v43, v54, v55, s[80:81]
    ds_bpermute_b32 v44, v42, v43
    s_waitcnt lgkmcnt(0)
    v_and_b32 v18, v44, v14
    v_and_b32 v19, v44, v15
    v_and_b32 v20, v44, v16
    v_and_b32 v21, v44, v17
    s_nop 1
    v_mfma_f32_16x16x32_bf16 v[64:67], v[18:21], v[164:167], v[64:67]
    s_ff1_i32_b32 s65, s70
    s_cmp_eq_u32 s70, 0
    s_cbranch_scc1 LA2_spv_4
    s_bitset0_b32 s70, s65
    s_and_b32 s66, s65, 15
    s_lshl_b32 s66, s66, 2
    v_add_u32 v42, s66, v13
    s_cmp_ge_u32 s65, 16
    s_cselect_b64 s[80:81], -1, 0
    v_cndmask_b32_e64 v43, v54, v55, s[80:81]
    ds_bpermute_b32 v44, v42, v43
    s_waitcnt lgkmcnt(0)
    v_and_b32 v22, v44, v14
    v_and_b32 v23, v44, v15
    v_and_b32 v24, v44, v16
    v_and_b32 v25, v44, v17
    s_nop 1
    v_mfma_f32_16x16x32_bf16 v[64:67], v[22:25], v[168:171], v[64:67]
    s_ff1_i32_b32 s65, s70
    s_cmp_eq_u32 s70, 0
    s_cbranch_scc1 LA2_spv_4
    s_bitset0_b32 s70, s65
    s_and_b32 s66, s65, 15
    s_lshl_b32 s66, s66, 2
    v_add_u32 v42, s66, v13
    s_cmp_ge_u32 s65, 16
    s_cselect_b64 s[80:81], -1, 0
    v_cndmask_b32_e64 v43, v54, v55, s[80:81]
    ds_bpermute_b32 v44, v42, v43
    s_waitcnt lgkmcnt(0)
    v_and_b32 v18, v44, v14
    v_and_b32 v19, v44, v15
    v_and_b32 v20, v44, v16
    v_and_b32 v21, v44, v17
    s_nop 1
    v_mfma_f32_16x16x32_bf16 v[64:67], v[18:21], v[172:175], v[64:67]
    s_ff1_i32_b32 s65, s70
    s_cmp_eq_u32 s70, 0
    s_cbranch_scc1 LA2_spv_4
    s_bitset0_b32 s70, s65
    s_and_b32 s66, s65, 15
    s_lshl_b32 s66, s66, 2
    v_add_u32 v42, s66, v13
    s_cmp_ge_u32 s65, 16
    s_cselect_b64 s[80:81], -1, 0
    v_cndmask_b32_e64 v43, v54, v55, s[80:81]
    ds_bpermute_b32 v44, v42, v43
    s_waitcnt lgkmcnt(0)
    v_and_b32 v22, v44, v14
    v_and_b32 v23, v44, v15
    v_and_b32 v24, v44, v16
    v_and_b32 v25, v44, v17
    s_nop 1
    v_mfma_f32_16x16x32_bf16 v[64:67], v[22:25], v[176:179], v[64:67]
    s_ff1_i32_b32 s65, s70
    s_cmp_eq_u32 s70, 0
    s_cbranch_scc1 LA2_spv_4
    s_bitset0_b32 s70, s65
    s_and_b32 s66, s65, 15
    s_lshl_b32 s66, s66, 2
    v_add_u32 v42, s66, v13
    s_cmp_ge_u32 s65, 16
    s_cselect_b64 s[80:81], -1, 0
    v_cndmask_b32_e64 v43, v54, v55, s[80:81]
    ds_bpermute_b32 v44, v42, v43
    s_waitcnt lgkmcnt(0)
    v_and_b32 v18, v44, v14
    v_and_b32 v19, v44, v15
    v_and_b32 v20, v44, v16
    v_and_b32 v21, v44, v17
    s_nop 1
    v_mfma_f32_16x16x32_bf16 v[64:67], v[18:21], v[180:183], v[64:67]
    s_ff1_i32_b32 s65, s70
    s_cmp_eq_u32 s70, 0
    s_cbranch_scc1 LA2_spv_4
    s_bitset0_b32 s70, s65
    s_and_b32 s66, s65, 15
    s_lshl_b32 s66, s66, 2
    v_add_u32 v42, s66, v13
    s_cmp_ge_u32 s65, 16
    s_cselect_b64 s[80:81], -1, 0
    v_cndmask_b32_e64 v43, v54, v55, s[80:81]
    ds_bpermute_b32 v44, v42, v43
    s_waitcnt lgkmcnt(0)
    v_and_b32 v22, v44, v14
    v_and_b32 v23, v44, v15
    v_and_b32 v24, v44, v16
    v_and_b32 v25, v44, v17
    s_nop 1
    v_mfma_f32_16x16x32_bf16 v[64:67], v[22:25], v[184:187], v[64:67]
LA2_spv_4:
    s_mov_b32 exec_hi, 0
    s_nop 6
    ds_write_b128 v10, v[64:67] offset:8704
    s_mov_b32 exec_hi, -1
    s_waitcnt lgkmcnt(0)
    s_barrier
    ds_read_b64 v[42:43], v9 offset:8704
    s_waitcnt lgkmcnt(0)
    v_add_f32_dpp v42, v42, v42 row_ror:2 row_mask:0xf bank_mask:0xf
    v_add_f32_dpp v43, v43, v43 row_ror:2 row_mask:0xf bank_mask:0xf
    s_nop 0
    v_add_f32_dpp v42, v42, v42 row_ror:4 row_mask:0xf bank_mask:0xf
    v_add_f32_dpp v43, v43, v43 row_ror:4 row_mask:0xf bank_mask:0xf
    s_nop 0
    v_add_f32_dpp v26, v42, v42 row_ror:8 row_mask:0xf bank_mask:0xf
    v_add_f32_dpp v28, v43, v43 row_ror:8 row_mask:0xf bank_mask:0xf
    s_mov_b64 exec, s[68:69]
    buffer_store_dwordx4 v[26:29], v8, s[56:59], s83 offen sc1
    s_mov_b64 exec, -1
    s_barrier
    buffer_load_dwordx4 v[38:41], v7, s[56:59], 0 offen offset:0 sc1
    s_mov_b64 s[78:79], 0
    buffer_load_dwordx4 v[124:127], v6, s[56:59], 0 offen sc1
    s_waitcnt vmcnt(1)
LA2_chk_5:
    v_cmp_eq_u32 vcc, s29, v39
    v_cmp_eq_u32 s[80:81], s29, v41
    s_and_b64 vcc, vcc, s[80:81]
    s_cmp_eq_u64 vcc, -1
    s_cbranch_scc1 LA2_ok_6
    s_sub_u32 s82, s82, 1
    s_cbranch_scc1 LA2_ok_6
    s_andn2_b64 exec, -1, vcc
    buffer_load_dwordx4 v[38:41], v7, s[56:59], 0 offen offset:0 sc1
    s_mov_b64 exec, -1
    s_waitcnt vmcnt(0)
    s_branch LA2_chk_5
LA2_ok_6:
    v_mov_b32 v42, v38
    s_nop 1
    v_max_f32_dpp v42, v42, v42 row_ror:2 row_mask:0xf bank_mask:0xf
    s_nop 1
    v_max_f32_dpp v42, v42, v42 row_ror:4 row_mask:0xf bank_mask:0xf
    s_nop 1
    v_max_f32_dpp v42, v42, v42 row_ror:8 row_mask:0xf bank_mask:0xf
    v_sub_f32 v43, v38, v42
    v_mul_f32 v43, 0x3fb8aa3b, v43
    v_exp_f32 v43, v43
    s_nop 0
    v_cndmask_b32_e64 v43, 0, v43, s[72:73]
    v_mul_f32 v44, v43, v40
    s_nop 1
    v_add_f32_dpp v44, v44, v44 row_ror:2 row_mask:0xf bank_mask:0xf
    s_nop 1
    v_add_f32_dpp v44, v44, v44 row_ror:4 row_mask:0xf bank_mask:0xf
    s_nop 1
    v_add_f32_dpp v44, v44, v44 row_ror:8 row_mask:0xf bank_mask:0xf
    v_rcp_f32 v44, v44
    s_nop 0
    v_mul_f32 v11, v43, v44
LA2_poll_7:
    s_waitcnt vmcnt(0)
    v_cmp_eq_u32 vcc, s29, v125
    v_cmp_eq_u32 s[80:81], s29, v127
    s_and_b64 vcc, vcc, s[80:81]
    s_andn2_b64 s[18:19], vcc, s[78:79]
    s_or_b64 s[78:79], s[78:79], vcc
    v_cndmask_b32_e64 v30, v30, v124, s[18:19]
    v_cndmask_b32_e64 v32, v32, v126, s[18:19]
    s_cmp_eq_u64 s[78:79], -1
    s_cbranch_scc1 LA2_pdone_8
    s_andn2_b64 exec, -1, s[78:79]
    buffer_load_dwordx4 v[124:127], v6, s[56:59], 0 offen sc1
    s_mov_b64 exec, -1
    s_sub_u32 s82, s82, 1
    s_cbranch_scc0 LA2_poll_7
LA2_pdone_8:
    v_mul_f32 v30, v30, v11
    v_mul_f32 v32, v32, v11
    s_nop 0
    v_add_f32_dpp v30, v30, v30 row_ror:2 row_mask:0xf bank_mask:0xf
    v_add_f32_dpp v32, v32, v32 row_ror:2 row_mask:0xf bank_mask:0xf
    s_nop 0
    v_add_f32_dpp v30, v30, v30 row_ror:4 row_mask:0xf bank_mask:0xf
    v_add_f32_dpp v32, v32, v32 row_ror:4 row_mask:0xf bank_mask:0xf
    s_nop 0
    v_add_f32_dpp v30, v30, v30 row_ror:8 row_mask:0xf bank_mask:0xf
    v_add_f32_dpp v32, v32, v32 row_ror:8 row_mask:0xf bank_mask:0xf
    v_cvt_pk_bf16_f32 v42, v30, v30
    v_cvt_pk_bf16_f32 v43, v32, v32
    s_nop 0
    v_and_b32_dpp v108, v42, v14 quad_perm:[0,0,0,0] row_mask:0xf bank_mask:0xf
    v_and_b32_dpp v109, v42, v15 quad_perm:[0,0,0,0] row_mask:0xf bank_mask:0xf
    v_and_b32_dpp v110, v42, v16 quad_perm:[0,0,0,0] row_mask:0xf bank_mask:0xf
    v_and_b32_dpp v111, v42, v17 quad_perm:[0,0,0,0] row_mask:0xf bank_mask:0xf
    s_nop 1
    v_mfma_f32_16x16x32_bf16 v[64:67], v[108:111], v[76:79], 0
    v_and_b32_dpp v112, v43, v14 quad_perm:[0,0,0,0] row_mask:0xf bank_mask:0xf
    v_and_b32_dpp v113, v43, v15 quad_perm:[0,0,0,0] row_mask:0xf bank_mask:0xf
    v_and_b32_dpp v114, v43, v16 quad_perm:[0,0,0,0] row_mask:0xf bank_mask:0xf
    v_and_b32_dpp v115, v43, v17 quad_perm:[0,0,0,0] row_mask:0xf bank_mask:0xf
    s_nop 1
    v_mfma_f32_16x16x32_bf16 v[64:67], v[112:115], v[80:83], v[64:67]
    v_and_b32_dpp v116, v42, v14 quad_perm:[1,1,1,1] row_mask:0xf bank_mask:0xf
    v_and_b32_dpp v117, v42, v15 quad_perm:[1,1,1,1] row_mask:0xf bank_mask:0xf
    v_and_b32_dpp v118, v42, v16 quad_perm:[1,1,1,1] row_mask:0xf bank_mask:0xf
    v_and_b32_dpp v119, v42, v17 quad_perm:[1,1,1,1] row_mask:0xf bank_mask:0xf
    s_nop 1
    v_mfma_f32_16x16x32_bf16 v[64:67], v[116:119], v[84:87], v[64:67]
    v_and_b32_dpp v120, v43, v14 quad_perm:[1,1,1,1] row_mask:0xf bank_mask:0xf
    v_and_b32_dpp v121, v43, v15 quad_perm:[1,1,1,1] row_mask:0xf bank_mask:0xf
    v_and_b32_dpp v122, v43, v16 quad_perm:[1,1,1,1] row_mask:0xf bank_mask:0xf
    v_and_b32_dpp v123, v43, v17 quad_perm:[1,1,1,1] row_mask:0xf bank_mask:0xf
    s_nop 1
    v_mfma_f32_16x16x32_bf16 v[64:67], v[120:123], v[88:91], v[64:67]
    s_mov_b32 exec_hi, 0
    s_nop 6
    ds_write_b128 v10, v[64:67] offset:0
    s_mov_b32 exec_hi, -1
    s_waitcnt lgkmcnt(0)
    s_barrier
    ds_read_b64 v[42:43], v9 offset:0
    s_waitcnt lgkmcnt(0)
    v_add_f32_dpp v42, v42, v42 row_ror:2 row_mask:0xf bank_mask:0xf
    v_add_f32_dpp v43, v43, v43 row_ror:2 row_mask:0xf bank_mask:0xf
    s_nop 0
    v_add_f32_dpp v42, v42, v42 row_ror:4 row_mask:0xf bank_mask:0xf
    v_add_f32_dpp v43, v43, v43 row_ror:4 row_mask:0xf bank_mask:0xf
    s_nop 0
    v_add_f32_dpp v26, v42, v42 row_ror:8 row_mask:0xf bank_mask:0xf
    v_add_f32_dpp v28, v43, v43 row_ror:8 row_mask:0xf bank_mask:0xf
    s_mov_b64 exec, s[68:69]
    buffer_store_dwordx4 v[26:29], v8, s[56:59], s84 offen sc1
    s_mov_b64 exec, -1
    s_barrier
    s_branch L_final
L_progA1:
    s_add_u32 s64, s31, 24576
    buffer_load_dwordx4 v[88:91], v2, s[44:47], s64 offen nt
    s_waitcnt vmcnt(4)
    s_waitcnt vmcnt(3)
    buffer_load_dwordx4 v[92:95], v1, s[36:39], 0 offen nt
    v_perm_b32 v42, v56, v56, s85
    v_and_b32 v18, v42, v14
    v_and_b32 v19, v42, v15
    v_and_b32 v20, v42, v16
    v_and_b32 v21, v42, v17
    s_nop 1
    v_mfma_f32_16x16x32_bf16 v[64:67], v[18:21], v[76:79], 0
    s_waitcnt vmcnt(3)
    s_mov_b32 s64, 8192
    buffer_load_dwordx4 v[96:99], v1, s[36:39], s64 offen nt
    v_perm_b32 v42, v56, v56, s86
    v_and_b32 v22, v42, v14
    v_and_b32 v23, v42, v15
    v_and_b32 v24, v42, v16
    v_and_b32 v25, v42, v17
    s_nop 1
    v_mfma_f32_16x16x32_bf16 v[64:67], v[22:25], v[80:83], v[64:67]
    s_waitcnt vmcnt(3)
    s_mov_b32 s64, 16384
    buffer_load_dwordx4 v[100:103], v1, s[36:39], s64 offen nt
    v_perm_b32 v42, v57, v57, s85
    v_and_b32 v18, v42, v14
    v_and_b32 v19, v42, v15
    v_and_b32 v20, v42, v16
    v_and_b32 v21, v42, v17
    s_nop 1
    v_mfma_f32_16x16x32_bf16 v[64:67], v[18:21], v[84:87], v[64:67]
    s_waitcnt vmcnt(3)
    s_mov_b32 s64, 24576
    buffer_load_dwordx4 v[104:107], v1, s[36:39], s64 offen nt
    v_perm_b32 v42, v57, v57, s86
    v_and_b32 v22, v42, v14
    v_and_b32 v23, v42, v15
    v_and_b32 v24, v42, v16
    v_and_b32 v25, v42, v17
    s_nop 1
    v_mfma_f32_16x16x32_bf16 v[64:67], v[22:25], v[88:91], v[64:67]
    s_mov_b32 exec_hi, 0
    s_nop 6
    ds_write_b128 v10, v[64:67] offset:13056
    s_mov_b32 exec_hi, -1
    s_waitcnt lgkmcnt(0)
    s_barrier
    s_waitcnt lgkmcnt(0)
    s_mul_i32 s29, s28, 0x9e3779b1
    s_add_u32 s29, s29, 0x7f4a7c15
    v_mov_b32 v27, s29
    v_mov_b32 v29, s29
    ds_read_b64 v[42:43], v9 offset:13056
    s_waitcnt lgkmcnt(0)
    v_add_f32_dpp v42, v42, v42 row_ror:2 row_mask:0xf bank_mask:0xf
    v_add_f32_dpp v43, v43, v43 row_ror:2 row_mask:0xf bank_mask:0xf
    s_nop 0
    v_add_f32_dpp v42, v42, v42 row_ror:4 row_mask:0xf bank_mask:0xf
    v_add_f32_dpp v43, v43, v43 row_ror:4 row_mask:0xf bank_mask:0xf
    s_nop 0
    v_add_f32_dpp v26, v42, v42 row_ror:8 row_mask:0xf bank_mask:0xf
    v_add_f32_dpp v28, v43, v43 row_ror:8 row_mask:0xf bank_mask:0xf
    s_mov_b64 exec, s[68:69]
    buffer_store_dwordx4 v[26:29], v8, s[56:59], s87 offen sc1
    s_mov_b64 exec, -1
    s_waitcnt vmcnt(4)
    s_mov_b32 s64, 32768
    buffer_load_dwordx4 v[108:111], v1, s[36:39], s64 offen nt
    s_waitcnt vmcnt(4)
    s_mov_b32 s64, 40960
    buffer_load_dwordx4 v[112:115], v1, s[36:39], s64 offen nt
    s_waitcnt vmcnt(4)
    s_mov_b32 s64, 49152
    buffer_load_dwordx4 v[116:119], v1, s[36:39], s64 offen nt
    s_waitcnt vmcnt(4)
    s_mov_b32 s64, 57344
    buffer_load_dwordx4 v[120:123], v1, s[36:39], s64 offen nt
    s_waitcnt vmcnt(3)
    s_mov_b32 s64, 65536
    buffer_load_dwordx4 v[124:127], v1, s[36:39], s64 offen nt
    s_waitcnt vmcnt(3)
    s_mov_b32 s64, 73728
    buffer_load_dwordx4 v[128:131], v1, s[36:39], s64 offen nt
    s_waitcnt vmcnt(3)
    s_mov_b32 s64, 81920
    buffer_load_dwordx4 v[132:135], v1, s[36:39], s64 offen nt
    s_waitcnt vmcnt(3)
    s_mov_b32 s64, 90112
    buffer_load_dwordx4 v[136:139], v1, s[36:39], s64 offen nt
    s_waitcnt vmcnt(3)
    s_mov_b32 s64, 98304
    buffer_load_dwordx4 v[140:143], v1, s[36:39], s64 offen nt
    s_waitcnt vmcnt(3)
    s_mov_b32 s64, 106496
    buffer_load_dwordx4 v[144:147], v1, s[36:39], s64 offen nt
    s_waitcnt vmcnt(3)
    s_mov_b32 s64, 114688
    buffer_load_dwordx4 v[148:151], v1, s[36:39], s64 offen nt
    s_waitcnt vmcnt(3)
    s_mov_b32 s64, 122880
    buffer_load_dwordx4 v[152:155], v1, s[36:39], s64 offen nt
    buffer_load_dwordx4 v[30:33], v5, s[56:59], 0 offen offset:0 sc1
    s_waitcnt vmcnt(4)
    s_mov_b32 s64, 131072
    buffer_load_dwordx4 v[156:159], v1, s[36:39], s64 offen nt
    s_waitcnt vmcnt(4)
    s_mov_b32 s64, 139264
    buffer_load_dwordx4 v[160:163], v1, s[36:39], s64 offen nt
    s_waitcnt vmcnt(4)
    s_mov_b32 s64, 147456
    buffer_load_dwordx4 v[164:167], v1, s[36:39], s64 offen nt
    s_waitcnt vmcnt(3)
LA1_chk_1:
    v_cmp_eq_u32 vcc, s29, v31
    v_cmp_eq_u32 s[80:81], s29, v33
    s_and_b64 vcc, vcc, s[80:81]
    s_cmp_eq_u64 vcc, -1
    s_cbranch_scc1 LA1_ok_2
    s_sub_u32 s82, s82, 1
    s_cbranch_scc1 LA1_ok_2
    s_andn2_b64 exec, -1, vcc
    buffer_load_dwordx4 v[30:33], v5, s[56:59], 0 offen offset:0 sc1
    s_mov_b64 exec, -1
    s_waitcnt vmcnt(0)
    s_branch LA1_chk_1
LA1_ok_2:
    v_cndmask_b32_e64 v30, 0, v30, s[24:25]
    v_cndmask_b32_e64 v32, 0, v32, s[24:25]
    s_nop 0
    v_add_f32_dpp v30, v30, v30 row_ror:2 row_mask:0xf bank_mask:0xf
    v_add_f32_dpp v32, v32, v32 row_ror:2 row_mask:0xf bank_mask:0xf
    s_nop 0
    v_add_f32_dpp v30, v30, v30 row_ror:4 row_mask:0xf bank_mask:0xf
    v_add_f32_dpp v32, v32, v32 row_ror:4 row_mask:0xf bank_mask:0xf
    s_nop 0
    v_add_f32_dpp v30, v30, v30 row_ror:8 row_mask:0xf bank_mask:0xf
    v_add_f32_dpp v32, v32, v32 row_ror:8 row_mask:0xf bank_mask:0xf
    v_cvt_pk_bf16_f32 v42, v30, v32
    s_mov_b64 exec, s[68:69]
    ds_write_b32 v72, v42
    s_mov_b64 exec, -1
    s_waitcnt lgkmcnt(0)
    s_barrier
    ds_read_b128 v[60:63], v73
    s_waitcnt lgkmcnt(0)
    v_dot2_f32_bf16 v92, v92, v60, 0
    v_dot2_f32_bf16 v96, v96, v60, 0
    v_dot2_f32_bf16 v100, v100, v60, 0
    v_dot2_f32_bf16 v104, v104, v60, 0
    v_dot2_f32_bf16 v92, v93, v61, v92
    v_dot2_f32_bf16 v96, v97, v61, v96
    v_dot2_f32_bf16 v100, v101, v61, v100
    v_dot2_f32_bf16 v104, v105, v61, v104
    v_dot2_f32_bf16 v92, v94, v62, v92
    v_dot2_f32_bf16 v96, v98, v62, v96
    v_dot2_f32_bf16 v100, v102, v62, v100
    v_dot2_f32_bf16 v104, v106, v62, v104
    v_dot2_f32_bf16 v92, v95, v63, v92
    v_dot2_f32_bf16 v96, v99, v63, v96
    v_dot2_f32_bf16 v100, v103, v63, v100
    v_dot2_f32_bf16 v104, v107, v63, v104
    v_dot2_f32_bf16 v108, v108, v60, 0
    v_dot2_f32_bf16 v112, v112, v60, 0
    v_dot2_f32_bf16 v116, v116, v60, 0
    v_dot2_f32_bf16 v120, v120, v60, 0
    v_dot2_f32_bf16 v108, v109, v61, v108
    v_dot2_f32_bf16 v112, v113, v61, v112
    v_dot2_f32_bf16 v116, v117, v61, v116
    v_dot2_f32_bf16 v120, v121, v61, v120
    v_dot2_f32_bf16 v108, v110, v62, v108
    v_dot2_f32_bf16 v112, v114, v62, v112
    v_dot2_f32_bf16 v116, v118, v62, v116
    v_dot2_f32_bf16 v120, v122, v62, v120
    v_dot2_f32_bf16 v108, v111, v63, v108
    v_dot2_f32_bf16 v112, v115, v63, v112
    v_dot2_f32_bf16 v116, v119, v63, v116
    v_dot2_f32_bf16 v120, v123, v63, v120
    s_mov_b32 s64, 155648
    buffer_load_dwordx4 v[168:171], v1, s[36:39], s64 offen nt
    v_dot2_f32_bf16 v124, v124, v60, 0
    v_dot2_f32_bf16 v128, v128, v60, 0
    v_dot2_f32_bf16 v132, v132, v60, 0
    v_dot2_f32_bf16 v136, v136, v60, 0
    v_dot2_f32_bf16 v124, v125, v61, v124
    v_dot2_f32_bf16 v128, v129, v61, v128
    v_dot2_f32_bf16 v132, v133, v61, v132
    v_dot2_f32_bf16 v136, v137, v61, v136
    v_dot2_f32_bf16 v124, v126, v62, v124
    v_dot2_f32_bf16 v128, v130, v62, v128
    v_dot2_f32_bf16 v132, v134, v62, v132
    v_dot2_f32_bf16 v136, v138, v62, v136
    v_dot2_f32_bf16 v124, v127, v63, v124
    v_dot2_f32_bf16 v128, v131, v63, v128
    v_dot2_f32_bf16 v132, v135, v63, v132
    v_dot2_f32_bf16 v136, v139, v63, v136
    v_dot2_f32_bf16 v140, v140, v60, 0
    v_dot2_f32_bf16 v144, v144, v60, 0
    v_dot2_f32_bf16 v148, v148, v60, 0
    v_dot2_f32_bf16 v152, v152, v60, 0
    v_dot2_f32_bf16 v140, v141, v61, v140
    v_dot2_f32_bf16 v144, v145, v61, v144
    v_dot2_f32_bf16 v148, v149, v61, v148
    v_dot2_f32_bf16 v152, v153, v61, v152
    v_dot2_f32_bf16 v140, v142, v62, v140
    v_dot2_f32_bf16 v144, v146, v62, v144
    v_dot2_f32_bf16 v148, v150, v62, v148
    v_dot2_f32_bf16 v152, v154, v62, v152
    v_dot2_f32_bf16 v140, v143, v63, v140
    v_dot2_f32_bf16 v144, v147, v63, v144
    v_dot2_f32_bf16 v148, v151, v63, v148
    v_dot2_f32_bf16 v152, v155, v63, v152
    v_add_f32_dpp v92, v92, v92 row_ror:8 row_mask:0xf bank_mask:0x3
    v_add_f32_dpp v96, v96, v96 row_ror:8 row_mask:0xf bank_mask:0x3
    v_add_f32_dpp v100, v100, v100 row_ror:8 row_mask:0xf bank_mask:0x3
    v_add_f32_dpp v104, v104, v104 row_ror:8 row_mask:0xf bank_mask:0x3
    v_add_f32_dpp v108, v108, v108 row_ror:8 row_mask:0xf bank_mask:0x3
    v_add_f32_dpp v112, v112, v112 row_ror:8 row_mask:0xf bank_mask:0x3
    v_add_f32_dpp v116, v116, v116 row_ror:8 row_mask:0xf bank_mask:0x3
    v_add_f32_dpp v120, v120, v120 row_ror:8 row_mask:0xf bank_mask:0x3
    v_add_f32_dpp v92, v124, v124 row_ror:8 row_mask:0xf bank_mask:0xc
    v_add_f32_dpp v96, v128, v128 row_ror:8 row_mask:0xf bank_mask:0xc
    v_add_f32_dpp v100, v132, v132 row_ror:8 row_mask:0xf bank_mask:0xc
    v_add_f32_dpp v104, v136, v136 row_ror:8 row_mask:0xf bank_mask:0xc
    v_add_f32_dpp v108, v140, v140 row_ror:8 row_mask:0xf bank_mask:0xc
    v_add_f32_dpp v112, v144, v144 row_ror:8 row_mask:0xf bank_mask:0xc
    v_add_f32_dpp v116, v148, v148 row_ror:8 row_mask:0xf bank_mask:0xc
    v_add_f32_dpp v120, v152, v152 row_ror:8 row_mask:0xf bank_mask:0xc
    v_add_f32_dpp v92, v92, v92 row_half_mirror row_mask:0xf bank_mask:0x5
    v_add_f32_dpp v96, v96, v96 row_half_mirror row_mask:0xf bank_mask:0x5
    v_add_f32_dpp v100, v100, v100 row_half_mirror row_mask:0xf bank_mask:0x5
    v_add_f32_dpp v104, v104, v104 row_half_mirror row_mask:0xf bank_mask:0x5
    v_add_f32_dpp v92, v108, v108 row_half_mirror row_mask:0xf bank_mask:0xa
    v_add_f32_dpp v96, v112, v112 row_half_mirror row_mask:0xf bank_mask:0xa
    v_add_f32_dpp v100, v116, v116 row_half_mirror row_mask:0xf bank_mask:0xa
    v_add_f32_dpp v104, v120, v120 row_half_mirror row_mask:0xf bank_mask:0xa
    v_add_f32_dpp v42, v92, v92 quad_perm:[2,3,0,1] row_mask:0xf bank_mask:0xf
    v_add_f32_dpp v43, v100, v100 quad_perm:[2,3,0,1] row_mask:0xf bank_mask:0xf
    v_add_f32_dpp v44, v96, v96 quad_perm:[2,3,0,1] row_mask:0xf bank_mask:0xf
    v_add_f32_dpp v45, v104, v104 quad_perm:[2,3,0,1] row_mask:0xf bank_mask:0xf
    v_cndmask_b32_e64 v46, v42, v43, s[74:75]
    v_cndmask_b32_e64 v47, v44, v45, s[74:75]
    s_nop 0
    v_add_f32_dpp v42, v46, v46 quad_perm:[1,0,3,2] row_mask:0xf bank_mask:0xf
    v_add_f32_dpp v43, v47, v47 quad_perm:[1,0,3,2] row_mask:0xf bank_mask:0xf
    v_cndmask_b32_e64 v50, v42, v43, s[76:77]
    v_cvt_pk_bf16_f32 v50, v50, v50
    v_and_b32 v50, 0xffff0000, v50
    v_mul_f32 v50, 0x3db504f3, v50
    v_cvt_pk_bf16_f32 v50, v50, v50
    v_and_b32 v50, 0xffff0000, v50
    s_waitcnt vmcnt(3)
    s_mov_b32 s64, 163840
    buffer_load_dwordx4 v[172:175], v1, s[36:39], s64 offen nt
    v_dot2_f32_bf16 v156, v156, v60, 0
    v_dot2_f32_bf16 v156, v157, v61, v156
    v_dot2_f32_bf16 v156, v158, v62, v156
    v_dot2_f32_bf16 v156, v159, v63, v156
    s_waitcnt vmcnt(3)
    s_mov_b32 s64, 172032
    buffer_load_dwordx4 v[176:179], v1, s[36:39], s64 offen nt
    v_dot2_f32_bf16 v160, v160, v60, 0
    v_dot2_f32_bf16 v160, v161, v61, v160
    v_dot2_f32_bf16 v160, v162, v62, v160
    v_dot2_f32_bf16 v160, v163, v63, v160
    s_waitcnt vmcnt(3)
    s_mov_b32 s64, 180224
    buffer_load_dwordx4 v[180:183], v1, s[36:39], s64 offen nt
    v_dot2_f32_bf16 v164, v164, v60, 0
    v_dot2_f32_bf16 v164, v165, v61, v164
    v_dot2_f32_bf16 v164, v166, v62, v164
    v_dot2_f32_bf16 v164, v167, v63, v164
    s_waitcnt vmcnt(3)
    s_mov_b32 s64, 188416
    buffer_load_dwordx4 v[184:187], v1, s[36:39], s64 offen nt
    v_dot2_f32_bf16 v168, v168, v60, 0
    v_dot2_f32_bf16 v168, v169, v61, v168
    v_dot2_f32_bf16 v168, v170, v62, v168
    v_dot2_f32_bf16 v168, v171, v63, v168
    s_waitcnt vmcnt(3)
    buffer_load_dwordx4 v[76:79], v3, s[48:51], 0 offen offset:0 nt
    v_dot2_f32_bf16 v172, v172, v60, 0
    v_dot2_f32_bf16 v172, v173, v61, v172
    v_dot2_f32_bf16 v172, v174, v62, v172
    v_dot2_f32_bf16 v172, v175, v63, v172
    s_waitcnt vmcnt(3)
    buffer_load_dwordx4 v[80:83], v3, s[48:51], 0 offen offset:1280 nt
    v_dot2_f32_bf16 v176, v176, v60, 0
    v_dot2_f32_bf16 v176, v177, v61, v176
    v_dot2_f32_bf16 v176, v178, v62, v176
    v_dot2_f32_bf16 v176, v179, v63, v176
    s_waitcnt vmcnt(3)
    buffer_load_dwordx4 v[84:87], v3, s[48:51], 0 offen offset:2560 nt
    v_dot2_f32_bf16 v180, v180, v60, 0
    v_dot2_f32_bf16 v180, v181, v61, v180
    v_dot2_f32_bf16 v180, v182, v62, v180
    v_dot2_f32_bf16 v180, v183, v63, v180
    s_waitcnt vmcnt(3)
    buffer_load_dwordx4 v[88:91], v3, s[48:51], 0 offen offset:3840 nt
    v_dot2_f32_bf16 v184, v184, v60, 0
    v_dot2_f32_bf16 v184, v185, v61, v184
    v_dot2_f32_bf16 v184, v186, v62, v184
    v_dot2_f32_bf16 v184, v187, v63, v184
    v_add_f32_dpp v156, v156, v156 row_ror:8 row_mask:0xf bank_mask:0xf
    v_add_f32_dpp v160, v160, v160 row_ror:8 row_mask:0xf bank_mask:0xf
    v_add_f32_dpp v164, v164, v164 row_ror:8 row_mask:0xf bank_mask:0xf
    v_add_f32_dpp v168, v168, v168 row_ror:8 row_mask:0xf bank_mask:0xf
    v_add_f32_dpp v172, v172, v172 row_ror:8 row_mask:0xf bank_mask:0xf
    v_add_f32_dpp v176, v176, v176 row_ror:8 row_mask:0xf bank_mask:0xf
    v_add_f32_dpp v180, v180, v180 row_ror:8 row_mask:0xf bank_mask:0xf
    v_add_f32_dpp v184, v184, v184 row_ror:8 row_mask:0xf bank_mask:0xf
    v_add_f32_dpp v156, v156, v156 row_half_mirror row_mask:0xf bank_mask:0x5
    v_add_f32_dpp v160, v160, v160 row_half_mirror row_mask:0xf bank_mask:0x5
    v_add_f32_dpp v164, v164, v164 row_half_mirror row_mask:0xf bank_mask:0x5
    v_add_f32_dpp v168, v168, v168 row_half_mirror row_mask:0xf bank_mask:0x5
    v_add_f32_dpp v156, v172, v172 row_half_mirror row_mask:0xf bank_mask:0xa
    v_add_f32_dpp v160, v176, v176 row_half_mirror row_mask:0xf bank_mask:0xa
    v_add_f32_dpp v164, v180, v180 row_half_mirror row_mask:0xf bank_mask:0xa
    v_add_f32_dpp v168, v184, v184 row_half_mirror row_mask:0xf bank_mask:0xa
    v_add_f32_dpp v42, v156, v156 quad_perm:[2,3,0,1] row_mask:0xf bank_mask:0xf
    v_add_f32_dpp v43, v164, v164 quad_perm:[2,3,0,1] row_mask:0xf bank_mask:0xf
    v_add_f32_dpp v44, v160, v160 quad_perm:[2,3,0,1] row_mask:0xf bank_mask:0xf
    v_add_f32_dpp v45, v168, v168 quad_perm:[2,3,0,1] row_mask:0xf bank_mask:0xf
    v_cndmask_b32_e64 v46, v42, v43, s[74:75]
    v_cndmask_b32_e64 v47, v44, v45, s[74:75]
    s_nop 0
    v_add_f32_dpp v42, v46, v46 quad_perm:[1,0,3,2] row_mask:0xf bank_mask:0xf
    v_add_f32_dpp v43, v47, v47 quad_perm:[1,0,3,2] row_mask:0xf bank_mask:0xf
    v_cndmask_b32_e64 v51, v42, v43, s[76:77]
    v_cvt_pk_bf16_f32 v51, v51, v51
    v_and_b32 v51, 0xffff0000, v51
    v_mul_f32 v51, 0x3db504f3, v51
    v_cvt_pk_bf16_f32 v51, v51, v51
    v_and_b32 v51, 0xffff0000, v51
    s_mov_b32 s80, 0x00ff00ff
    s_mov_b32 s81, 0x00ff00ff
    v_mov_b32 v42, 0xff800000
    v_cndmask_b32_e64 v51, v42, v51, s[80:81]
    v_max_f32 v12, v50, v51
    s_nop 1
    v_max_f32_dpp v12, v12, v12 row_ror:1 row_mask:0xf bank_mask:0xf
    s_nop 1
    v_max_f32_dpp v12, v12, v12 row_ror:2 row_mask:0xf bank_mask:0xf
    s_nop 1
    v_max_f32_dpp v12, v12, v12 row_ror:4 row_mask:0xf bank_mask:0xf
    s_nop 1
    v_max_f32_dpp v12, v12, v12 row_ror:8 row_mask:0xf bank_mask:0xf
    v_mov_b32 v42, v12
    s_nop 1
    v_permlane16_swap_b32 v12, v42
    v_max_f32 v12, v12, v42
    v_mov_b32 v42, v12
    s_nop 1
    v_permlane32_swap_b32 v12, v42
    v_max_f32 v12, v12, v42
    v_sub_f32 v52, v50, v12
    v_sub_f32 v53, v51, v12
    v_mul_f32 v50, 0x3fb8aa3b, v52
    v_mul_f32 v51, 0x3fb8aa3b, v53
    v_exp_f32 v50, v50
    v_exp_f32 v51, v51
    s_nop 0
    v_add_f32 v43, v50, v51
    s_nop 1
    v_add_f32_dpp v43, v43, v43 row_ror:1 row_mask:0xf bank_mask:0xf
    s_nop 1
    v_add_f32_dpp v43, v43, v43 row_ror:2 row_mask:0xf bank_mask:0xf
    s_nop 1
    v_add_f32_dpp v43, v43, v43 row_ror:4 row_mask:0xf bank_mask:0xf
    s_nop 1
    v_add_f32_dpp v43, v43, v43 row_ror:8 row_mask:0xf bank_mask:0xf
    v_mov_b32 v44, v43
    s_nop 1
    v_permlane16_swap_b32 v43, v44
    v_add_f32 v43, v43, v44
    v_mov_b32 v44, v43
    s_nop 1
    v_permlane32_swap_b32 v43, v44
    v_add_f32 v43, v43, v44
    v_mov_b32 v42, v12
    v_mov_b32 v44, s30
    v_lshlrev_b32 v44, 3, v44
    s_mov_b64 exec, 1
    ds_write_b64 v44, v[42:43] offset:22016
    s_mov_b64 exec, -1
    s_waitcnt lgkmcnt(0)
    s_barrier
    v_and_b32 v44, 7, v0
    v_lshlrev_b32 v44, 3, v44
    ds_read_b64 v[42:43], v44 offset:22016
    s_waitcnt lgkmcnt(0)
    v_max_f32_dpp v44, v42, v42 quad_perm:[1,0,3,2] row_mask:0xf bank_mask:0xf
    s_nop 1
    v_max_f32_dpp v44, v44, v44 quad_perm:[2,3,0,1] row_mask:0xf bank_mask:0xf
    s_nop 1
    v_max_f32_dpp v44, v44, v44 row_half_mirror row_mask:0xf bank_mask:0xf
    v_sub_f32 v46, v12, v44
    v_sub_f32 v45, v42, v44
    v_add_f32 v52, v52, v46
    v_add_f32 v53, v53, v46
    s_mov_b32 s65, 0xc2d00000
    v_cmp_le_f32 vcc, s65, v52
    v_cmp_le_f32 s[80:81], s65, v53
    s_or_b32 s66, vcc_lo, vcc_hi
    s_or_b32 s67, s80, s81
    s_lshr_b32 s65, s66, 16
    s_or_b32 s66, s66, s65
    s_and_b32 s66, s66, 0xffff
    s_lshl_b32 s65, s67, 16
    s_or_b32 s67, s67, s65
    s_and_b32 s67, s67, 0xffff0000
    s_or_b32 s70, s66, s67
    s_mov_b32 s71, s70
    s_ff1_i32_b32 s65, s71
    s_cmp_eq_u32 s71, 0
    s_cbranch_scc1 LA1_spi_3
    s_bitset0_b32 s71, s65
    s_lshl_b32 s65, s65, 13
    buffer_load_dwordx4 v[92:95], v1, s[40:43], s65 offen nt
    s_ff1_i32_b32 s65, s71
    s_cmp_eq_u32 s71, 0
    s_cbranch_scc1 LA1_spi_3
    s_bitset0_b32 s71, s65
    s_lshl_b32 s65, s65, 13
    buffer_load_dwordx4 v[96:99], v1, s[40:43], s65 offen nt
    s_ff1_i32_b32 s65, s71
    s_cmp_eq_u32 s71, 0
    s_cbranch_scc1 LA1_spi_3
    s_bitset0_b32 s71, s65
    s_lshl_b32 s65, s65, 13
    buffer_load_dwordx4 v[100:103], v1, s[40:43], s65 offen nt
    s_ff1_i32_b32 s65, s71
    s_cmp_eq_u32 s71, 0
    s_cbranch_scc1 LA1_spi_3
    s_bitset0_b32 s71, s65
    s_lshl_b32 s65, s65, 13
    buffer_load_dwordx4 v[104:107], v1, s[40:43], s65 offen nt
    s_ff1_i32_b32 s65, s71
    s_cmp_eq_u32 s71, 0
    s_cbranch_scc1 LA1_spi_3
    s_bitset0_b32 s71, s65
    s_lshl_b32 s65, s65, 13
    buffer_load_dwordx4 v[108:111], v1, s[40:43], s65 offen nt
    s_ff1_i32_b32 s65, s71
    s_cmp_eq_u32 s71, 0
    s_cbranch_scc1 LA1_spi_3
    s_bitset0_b32 s71, s65
    s_lshl_b32 s65, s65, 13
    buffer_load_dwordx4 v[112:115], v1, s[40:43], s65 offen nt
    s_ff1_i32_b32 s65, s71
    s_cmp_eq_u32 s71, 0
    s_cbranch_scc1 LA1_spi_3
    s_bitset0_b32 s71, s65
    s_lshl_b32 s65, s65, 13
    buffer_load_dwordx4 v[116:119], v1, s[40:43], s65 offen nt
    s_ff1_i32_b32 s65, s71
    s_cmp_eq_u32 s71, 0
    s_cbranch_scc1 LA1_spi_3
    s_bitset0_b32 s71, s65
    s_lshl_b32 s65, s65, 13
    buffer_load_dwordx4 v[120:123], v1, s[40:43], s65 offen nt
    s_ff1_i32_b32 s65, s71
    s_cmp_eq_u32 s71, 0
    s_cbranch_scc1 LA1_spi_3
    s_bitset0_b32 s71, s65
    s_lshl_b32 s65, s65, 13
    buffer_load_dwordx4 v[124:127], v1, s[40:43], s65 offen nt
    s_ff1_i32_b32 s65, s71
    s_cmp_eq_u32 s71, 0
    s_cbranch_scc1 LA1_spi_3
    s_bitset0_b32 s71, s65
    s_lshl_b32 s65, s65, 13
    buffer_load_dwordx4 v[128:131], v1, s[40:43], s65 offen nt
    s_ff1_i32_b32 s65, s71
    s_cmp_eq_u32 s71, 0
    s_cbranch_scc1 LA1_spi_3
    s_bitset0_b32 s71, s65
    s_lshl_b32 s65, s65, 13
    buffer_load_dwordx4 v[132:135], v1, s[40:43], s65 offen nt
    s_ff1_i32_b32 s65, s71
    s_cmp_eq_u32 s71, 0
    s_cbranch_scc1 LA1_spi_3
    s_bitset0_b32 s71, s65
    s_lshl_b32 s65, s65, 13
    buffer_load_dwordx4 v[136:139], v1, s[40:43], s65 offen nt
    s_ff1_i32_b32 s65, s71
    s_cmp_eq_u32 s71, 0
    s_cbranch_scc1 LA1_spi_3
    s_bitset0_b32 s71, s65
    s_lshl_b32 s65, s65, 13
    buffer_load_dwordx4 v[140:143], v1, s[40:43], s65 offen nt
    s_ff1_i32_b32 s65, s71
    s_cmp_eq_u32 s71, 0
    s_cbranch_scc1 LA1_spi_3
    s_bitset0_b32 s71, s65
    s_lshl_b32 s65, s65, 13
    buffer_load_dwordx4 v[144:147], v1, s[40:43], s65 offen nt
    s_ff1_i32_b32 s65, s71
    s_cmp_eq_u32 s71, 0
    s_cbranch_scc1 LA1_spi_3
    s_bitset0_b32 s71, s65
    s_lshl_b32 s65, s65, 13
    buffer_load_dwordx4 v[148:151], v1, s[40:43], s65 offen nt
    s_ff1_i32_b32 s65, s71
    s_cmp_eq_u32 s71, 0
    s_cbranch_scc1 LA1_spi_3
    s_bitset0_b32 s71, s65
    s_lshl_b32 s65, s65, 13
    buffer_load_dwordx4 v[152:155], v1, s[40:43], s65 offen nt
    s_ff1_i32_b32 s65, s71
    s_cmp_eq_u32 s71, 0
    s_cbranch_scc1 LA1_spi_3
    s_bitset0_b32 s71, s65
    s_lshl_b32 s65, s65, 13
    buffer_load_dwordx4 v[156:159], v1, s[40:43], s65 offen nt
    s_ff1_i32_b32 s65, s71
    s_cmp_eq_u32 s71, 0
    s_cbranch_scc1 LA1_spi_3
    s_bitset0_b32 s71, s65
    s_lshl_b32 s65, s65, 13
    buffer_load_dwordx4 v[160:163], v1, s[40:43], s65 offen nt
    s_ff1_i32_b32 s65, s71
    s_cmp_eq_u32 s71, 0
    s_cbranch_scc1 LA1_spi_3
    s_bitset0_b32 s71, s65
    s_lshl_b32 s65, s65, 13
    buffer_load_dwordx4 v[164:167], v1, s[40:43], s65 offen nt
    s_ff1_i32_b32 s65, s71
    s_cmp_eq_u32 s71, 0
    s_cbranch_scc1 LA1_spi_3
    s_bitset0_b32 s71, s65
    s_lshl_b32 s65, s65, 13
    buffer_load_dwordx4 v[168:171], v1, s[40:43], s65 offen nt
    s_ff1_i32_b32 s65, s71
    s_cmp_eq_u32 s71, 0
    s_cbranch_scc1 LA1_spi_3
    s_bitset0_b32 s71, s65
    s_lshl_b32 s65, s65, 13
    buffer_load_dwordx4 v[172:175], v1, s[40:43], s65 offen nt
    s_ff1_i32_b32 s65, s71
    s_cmp_eq_u32 s71, 0
    s_cbranch_scc1 LA1_spi_3
    s_bitset0_b32 s71, s65
    s_lshl_b32 s65, s65, 13
    buffer_load_dwordx4 v[176:179], v1, s[40:43], s65 offen nt
    s_ff1_i32_b32 s65, s71
    s_cmp_eq_u32 s71, 0
    s_cbranch_scc1 LA1_spi_3
    s_bitset0_b32 s71, s65
    s_lshl_b32 s65, s65, 13
    buffer_load_dwordx4 v[180:183], v1, s[40:43], s65 offen nt
    s_ff1_i32_b32 s65, s71
    s_cmp_eq_u32 s71, 0
    s_cbranch_scc1 LA1_spi_3
    s_bitset0_b32 s71, s65
    s_lshl_b32 s65, s65, 13
    buffer_load_dwordx4 v[184:187], v1, s[40:43], s65 offen nt
LA1_spi_3:
    v_mul_f32 v45, 0x3fb8aa3b, v45
    v_mul_f32 v46, 0x3fb8aa3b, v46
    v_exp_f32 v45, v45
    v_exp_f32 v46, v46
    v_mul_f32 v45, v45, v43
    v_mul_f32 v50, v50, v46
    v_mul_f32 v51, v51, v46
    v_add_f32_dpp v45, v45, v45 quad_perm:[1,0,3,2] row_mask:0xf bank_mask:0xf
    v_cvt_pk_bf16_f32 v54, v50, v50
    v_cvt_pk_bf16_f32 v55, v51, v51
    v_add_f32_dpp v45, v45, v45 quad_perm:[2,3,0,1] row_mask:0xf bank_mask:0xf
    s_nop 1
    v_add_f32_dpp v28, v45, v45 row_half_mirror row_mask:0xf bank_mask:0xf
    v_mov_b32 v26, v44
    v_mov_b32 v47, 1024
    s_mov_b64 exec, 1
    buffer_store_dwordx4 v[26:29], v47, s[56:59], s83 offen sc1
    s_mov_b64 exec, -1
    v_mov_b32 v64, 0
    v_mov_b32 v65, 0
    v_mov_b32 v66, 0
    v_mov_b32 v67, 0
    s_waitcnt vmcnt(1)
    s_ff1_i32_b32 s65, s70
    s_cmp_eq_u32 s70, 0
    s_cbranch_scc1 LA1_spv_4
    s_bitset0_b32 s70, s65
    s_and_b32 s66, s65, 15
    s_lshl_b32 s66, s66, 2
    v_add_u32 v42, s66, v13
    s_cmp_ge_u32 s65, 16
    s_cselect_b64 s[80:81], -1, 0
    v_cndmask_b32_e64 v43, v54, v55, s[80:81]
    ds_bpermute_b32 v44, v42, v43
    s_waitcnt lgkmcnt(0)
    v_and_b32 v18, v44, v14
    v_and_b32 v19, v44, v15
    v_and_b32 v20, v44, v16
    v_and_b32 v21, v44, v17
    s_nop 1
    v_mfma_f32_16x16x32_bf16 v[64:67], v[18:21], v[92:95], v[64:67]
    s_ff1_i32_b32 s65, s70
    s_cmp_eq_u32 s70, 0
    s_cbranch_scc1 LA1_spv_4
    s_bitset0_b32 s70, s65
    s_and_b32 s66, s65, 15
    s_lshl_b32 s66, s66, 2
    v_add_u32 v42, s66, v13
    s_cmp_ge_u32 s65, 16
    s_cselect_b64 s[80:81], -1, 0
    v_cndmask_b32_e64 v43, v54, v55, s[80:81]
    ds_bpermute_b32 v44, v42, v43
    s_waitcnt lgkmcnt(0)
    v_and_b32 v22, v44, v14
    v_and_b32 v23, v44, v15
    v_and_b32 v24, v44, v16
    v_and_b32 v25, v44, v17
    s_nop 1
    v_mfma_f32_16x16x32_bf16 v[64:67], v[22:25], v[96:99], v[64:67]
    s_ff1_i32_b32 s65, s70
    s_cmp_eq_u32 s70, 0
    s_cbranch_scc1 LA1_spv_4
    s_bitset0_b32 s70, s65
    s_and_b32 s66, s65, 15
    s_lshl_b32 s66, s66, 2
    v_add_u32 v42, s66, v13
    s_cmp_ge_u32 s65, 16
    s_cselect_b64 s[80:81], -1, 0
    v_cndmask_b32_e64 v43, v54, v55, s[80:81]
    ds_bpermute_b32 v44, v42, v43
    s_waitcnt lgkmcnt(0)
    v_and_b32 v18, v44, v14
    v_and_b32 v19, v44, v15
    v_and_b32 v20, v44, v16
    v_and_b32 v21, v44, v17
    s_nop 1
    v_mfma_f32_16x16x32_bf16 v[64:67], v[18:21], v[100:103], v[64:67]
    s_ff1_i32_b32 s65, s70
    s_cmp_eq_u32 s70, 0
    s_cbranch_scc1 LA1_spv_4
    s_bitset0_b32 s70, s65
    s_and_b32 s66, s65, 15
    s_lshl_b32 s66, s66, 2
    v_add_u32 v42, s66, v13
    s_cmp_ge_u32 s65, 16
    s_cselect_b64 s[80:81], -1, 0
    v_cndmask_b32_e64 v43, v54, v55, s[80:81]
    ds_bpermute_b32 v44, v42, v43
    s_waitcnt lgkmcnt(0)
    v_and_b32 v22, v44, v14
    v_and_b32 v23, v44, v15
    v_and_b32 v24, v44, v16
    v_and_b32 v25, v44, v17
    s_nop 1
    v_mfma_f32_16x16x32_bf16 v[64:67], v[22:25], v[104:107], v[64:67]
    s_ff1_i32_b32 s65, s70
    s_cmp_eq_u32 s70, 0
    s_cbranch_scc1 LA1_spv_4
    s_bitset0_b32 s70, s65
    s_and_b32 s66, s65, 15
    s_lshl_b32 s66, s66, 2
    v_add_u32 v42, s66, v13
    s_cmp_ge_u32 s65, 16
    s_cselect_b64 s[80:81], -1, 0
    v_cndmask_b32_e64 v43, v54, v55, s[80:81]
    ds_bpermute_b32 v44, v42, v43
    s_waitcnt lgkmcnt(0)
    v_and_b32 v18, v44, v14
    v_and_b32 v19, v44, v15
    v_and_b32 v20, v44, v16
    v_and_b32 v21, v44, v17
    s_nop 1
    v_mfma_f32_16x16x32_bf16 v[64:67], v[18:21], v[108:111], v[64:67]
    s_ff1_i32_b32 s65, s70
    s_cmp_eq_u32 s70, 0
    s_cbranch_scc1 LA1_spv_4
    s_bitset0_b32 s70, s65
    s_and_b32 s66, s65, 15
    s_lshl_b32 s66, s66, 2
    v_add_u32 v42, s66, v13
    s_cmp_ge_u32 s65, 16
    s_cselect_b64 s[80:81], -1, 0
    v_cndmask_b32_e64 v43, v54, v55, s[80:81]
    ds_bpermute_b32 v44, v42, v43
    s_waitcnt lgkmcnt(0)
    v_and_b32 v22, v44, v14
    v_and_b32 v23, v44, v15
    v_and_b32 v24, v44, v16
    v_and_b32 v25, v44, v17
    s_nop 1
    v_mfma_f32_16x16x32_bf16 v[64:67], v[22:25], v[112:115], v[64:67]
    s_ff1_i32_b32 s65, s70
    s_cmp_eq_u32 s70, 0
    s_cbranch_scc1 LA1_spv_4
    s_bitset0_b32 s70, s65
    s_and_b32 s66, s65, 15
    s_lshl_b32 s66, s66, 2
    v_add_u32 v42, s66, v13
    s_cmp_ge_u32 s65, 16
    s_cselect_b64 s[80:81], -1, 0
    v_cndmask_b32_e64 v43, v54, v55, s[80:81]
    ds_bpermute_b32 v44, v42, v43
    s_waitcnt lgkmcnt(0)
    v_and_b32 v18, v44, v14
    v_and_b32 v19, v44, v15
    v_and_b32 v20, v44, v16
    v_and_b32 v21, v44, v17
    s_nop 1
    v_mfma_f32_16x16x32_bf16 v[64:67], v[18:21], v[116:119], v[64:67]
    s_ff1_i32_b32 s65, s70
    s_cmp_eq_u32 s70, 0
    s_cbranch_scc1 LA1_spv_4
    s_bitset0_b32 s70, s65
    s_and_b32 s66, s65, 15
    s_lshl_b32 s66, s66, 2
    v_add_u32 v42, s66, v13
    s_cmp_ge_u32 s65, 16
    s_cselect_b64 s[80:81], -1, 0
    v_cndmask_b32_e64 v43, v54, v55, s[80:81]
    ds_bpermute_b32 v44, v42, v43
    s_waitcnt lgkmcnt(0)
    v_and_b32 v22, v44, v14
    v_and_b32 v23, v44, v15
    v_and_b32 v24, v44, v16
    v_and_b32 v25, v44, v17
    s_nop 1
    v_mfma_f32_16x16x32_bf16 v[64:67], v[22:25], v[120:123], v[64:67]
    s_ff1_i32_b32 s65, s70
    s_cmp_eq_u32 s70, 0
    s_cbranch_scc1 LA1_spv_4
    s_bitset0_b32 s70, s65
    s_and_b32 s66, s65, 15
    s_lshl_b32 s66, s66, 2
    v_add_u32 v42, s66, v13
    s_cmp_ge_u32 s65, 16
    s_cselect_b64 s[80:81], -1, 0
    v_cndmask_b32_e64 v43, v54, v55, s[80:81]
    ds_bpermute_b32 v44, v42, v43
    s_waitcnt lgkmcnt(0)
    v_and_b32 v18, v44, v14
    v_and_b32 v19, v44, v15
    v_and_b32 v20, v44, v16
    v_and_b32 v21, v44, v17
    s_nop 1
    v_mfma_f32_16x16x32_bf16 v[64:67], v[18:21], v[124:127], v[64:67]
    s_ff1_i32_b32 s65, s70
    s_cmp_eq_u32 s70, 0
    s_cbranch_scc1 LA1_spv_4
    s_bitset0_b32 s70, s65
    s_and_b32 s66, s65, 15
    s_lshl_b32 s66, s66, 2
    v_add_u32 v42, s66, v13
    s_cmp_ge_u32 s65, 16
    s_cselect_b64 s[80:81], -1, 0
    v_cndmask_b32_e64 v43, v54, v55, s[80:81]
    ds_bpermute_b32 v44, v42, v43
    s_waitcnt lgkmcnt(0)
    v_and_b32 v22, v44, v14
    v_and_b32 v23, v44, v15
    v_and_b32 v24, v44, v16
    v_and_b32 v25, v44, v17
    s_nop 1
    v_mfma_f32_16x16x32_bf16 v[64:67], v[22:25], v[128:131], v[64:67]
    s_ff1_i32_b32 s65, s70
    s_cmp_eq_u32 s70, 0
    s_cbranch_scc1 LA1_spv_4
    s_bitset0_b32 s70, s65
    s_and_b32 s66, s65, 15
    s_lshl_b32 s66, s66, 2
    v_add_u32 v42, s66, v13
    s_cmp_ge_u32 s65, 16
    s_cselect_b64 s[80:81], -1, 0
    v_cndmask_b32_e64 v43, v54, v55, s[80:81]
    ds_bpermute_b32 v44, v42, v43
    s_waitcnt lgkmcnt(0)
    v_and_b32 v18, v44, v14
    v_and_b32 v19, v44, v15
    v_and_b32 v20, v44, v16
    v_and_b32 v21, v44, v17
    s_nop 1
    v_mfma_f32_16x16x32_bf16 v[64:67], v[18:21], v[132:135], v[64:67]
    s_ff1_i32_b32 s65, s70
    s_cmp_eq_u32 s70, 0
    s_cbranch_scc1 LA1_spv_4
    s_bitset0_b32 s70, s65
    s_and_b32 s66, s65, 15
    s_lshl_b32 s66, s66, 2
    v_add_u32 v42, s66, v13
    s_cmp_ge_u32 s65, 16
    s_cselect_b64 s[80:81], -1, 0
    v_cndmask_b32_e64 v43, v54, v55, s[80:81]
    ds_bpermute_b32 v44, v42, v43
    s_waitcnt lgkmcnt(0)
    v_and_b32 v22, v44, v14
    v_and_b32 v23, v44, v15
    v_and_b32 v24, v44, v16
    v_and_b32 v25, v44, v17
    s_nop 1
    v_mfma_f32_16x16x32_bf16 v[64:67], v[22:25], v[136:139], v[64:67]
    s_ff1_i32_b32 s65, s70
    s_cmp_eq_u32 s70, 0
    s_cbranch_scc1 LA1_spv_4
    s_bitset0_b32 s70, s65
    s_and_b32 s66, s65, 15
    s_lshl_b32 s66, s66, 2
    v_add_u32 v42, s66, v13
    s_cmp_ge_u32 s65, 16
    s_cselect_b64 s[80:81], -1, 0
    v_cndmask_b32_e64 v43, v54, v55, s[80:81]
    ds_bpermute_b32 v44, v42, v43
    s_waitcnt lgkmcnt(0)
    v_and_b32 v18, v44, v14
    v_and_b32 v19, v44, v15
    v_and_b32 v20, v44, v16
    v_and_b32 v21, v44, v17
    s_nop 1
    v_mfma_f32_16x16x32_bf16 v[64:67], v[18:21], v[140:143], v[64:67]
    s_ff1_i32_b32 s65, s70
    s_cmp_eq_u32 s70, 0
    s_cbranch_scc1 LA1_spv_4
    s_bitset0_b32 s70, s65
    s_and_b32 s66, s65, 15
    s_lshl_b32 s66, s66, 2
    v_add_u32 v42, s66, v13
    s_cmp_ge_u32 s65, 16
    s_cselect_b64 s[80:81], -1, 0
    v_cndmask_b32_e64 v43, v54, v55, s[80:81]
    ds_bpermute_b32 v44, v42, v43
    s_waitcnt lgkmcnt(0)
    v_and_b32 v22, v44, v14
    v_and_b32 v23, v44, v15
    v_and_b32 v24, v44, v16
    v_and_b32 v25, v44, v17
    s_nop 1
    v_mfma_f32_16x16x32_bf16 v[64:67], v[22:25], v[144:147], v[64:67]
    s_ff1_i32_b32 s65, s70
    s_cmp_eq_u32 s70, 0
    s_cbranch_scc1 LA1_spv_4
    s_bitset0_b32 s70, s65
    s_and_b32 s66, s65, 15
    s_lshl_b32 s66, s66, 2
    v_add_u32 v42, s66, v13
    s_cmp_ge_u32 s65, 16
    s_cselect_b64 s[80:81], -1, 0
    v_cndmask_b32_e64 v43, v54, v55, s[80:81]
    ds_bpermute_b32 v44, v42, v43
    s_waitcnt lgkmcnt(0)
    v_and_b32 v18, v44, v14
    v_and_b32 v19, v44, v15
    v_and_b32 v20, v44, v16
    v_and_b32 v21, v44, v17
    s_nop 1
    v_mfma_f32_16x16x32_bf16 v[64:67], v[18:21], v[148:151], v[64:67]
    s_ff1_i32_b32 s65, s70
    s_cmp_eq_u32 s70, 0
    s_cbranch_scc1 LA1_spv_4
    s_bitset0_b32 s70, s65
    s_and_b32 s66, s65, 15
    s_lshl_b32 s66, s66, 2
    v_add_u32 v42, s66, v13
    s_cmp_ge_u32 s65, 16
    s_cselect_b64 s[80:81], -1, 0
    v_cndmask_b32_e64 v43, v54, v55, s[80:81]
    ds_bpermute_b32 v44, v42, v43
    s_waitcnt lgkmcnt(0)
    v_and_b32 v22, v44, v14
    v_and_b32 v23, v44, v15
    v_and_b32 v24, v44, v16
    v_and_b32 v25, v44, v17
    s_nop 1
    v_mfma_f32_16x16x32_bf16 v[64:67], v[22:25], v[152:155], v[64:67]
    s_ff1_i32_b32 s65, s70
    s_cmp_eq_u32 s70, 0
    s_cbranch_scc1 LA1_spv_4
    s_bitset0_b32 s70, s65
    s_and_b32 s66, s65, 15
    s_lshl_b32 s66, s66, 2
    v_add_u32 v42, s66, v13
    s_cmp_ge_u32 s65, 16
    s_cselect_b64 s[80:81], -1, 0
    v_cndmask_b32_e64 v43, v54, v55, s[80:81]
    ds_bpermute_b32 v44, v42, v43
    s_waitcnt lgkmcnt(0)
    v_and_b32 v18, v44, v14
    v_and_b32 v19, v44, v15
    v_and_b32 v20, v44, v16
    v_and_b32 v21, v44, v17
    s_nop 1
    v_mfma_f32_16x16x32_bf16 v[64:67], v[18:21], v[156:159], v[64:67]
    s_ff1_i32_b32 s65, s70
    s_cmp_eq_u32 s70, 0
    s_cbranch_scc1 LA1_spv_4
    s_bitset0_b32 s70, s65
    s_and_b32 s66, s65, 15
    s_lshl_b32 s66, s66, 2
    v_add_u32 v42, s66, v13
    s_cmp_ge_u32 s65, 16
    s_cselect_b64 s[80:81], -1, 0
    v_cndmask_b32_e64 v43, v54, v55, s[80:81]
    ds_bpermute_b32 v44, v42, v43
    s_waitcnt lgkmcnt(0)
    v_and_b32 v22, v44, v14
    v_and_b32 v23, v44, v15
    v_and_b32 v24, v44, v16
    v_and_b32 v25, v44, v17
    s_nop 1
    v_mfma_f32_16x16x32_bf16 v[64:67], v[22:25], v[160:163], v[64:67]
    s_ff1_i32_b32 s65, s70
    s_cmp_eq_u32 s70, 0
    s_cbranch_scc1 LA1_spv_4
    s_bitset0_b32 s70, s65
    s_and_b32 s66, s65, 15
    s_lshl_b32 s66, s66, 2
    v_add_u32 v42, s66, v13
    s_cmp_ge_u32 s65, 16
    s_cselect_b64 s[80:81], -1, 0
    v_cndmask_b32_e64 v43, v54, v55, s[80:81]
    ds_bpermute_b32 v44, v42, v43
    s_waitcnt lgkmcnt(0)
    v_and_b32 v18, v44, v14
    v_and_b32 v19, v44, v15
    v_and_b32 v20, v44, v16
    v_and_b32 v21, v44, v17
    s_nop 1
    v_mfma_f32_16x16x32_bf16 v[64:67], v[18:21], v[164:167], v[64:67]
    s_ff1_i32_b32 s65, s70
    s_cmp_eq_u32 s70, 0
    s_cbranch_scc1 LA1_spv_4
    s_bitset0_b32 s70, s65
    s_and_b32 s66, s65, 15
    s_lshl_b32 s66, s66, 2
    v_add_u32 v42, s66, v13
    s_cmp_ge_u32 s65, 16
    s_cselect_b64 s[80:81], -1, 0
    v_cndmask_b32_e64 v43, v54, v55, s[80:81]
    ds_bpermute_b32 v44, v42, v43
    s_waitcnt lgkmcnt(0)
    v_and_b32 v22, v44, v14
    v_and_b32 v23, v44, v15
    v_and_b32 v24, v44, v16
    v_and_b32 v25, v44, v17
    s_nop 1
    v_mfma_f32_16x16x32_bf16 v[64:67], v[22:25], v[168:171], v[64:67]
    s_ff1_i32_b32 s65, s70
    s_cmp_eq_u32 s70, 0
    s_cbranch_scc1 LA1_spv_4
    s_bitset0_b32 s70, s65
    s_and_b32 s66, s65, 15
    s_lshl_b32 s66, s66, 2
    v_add_u32 v42, s66, v13
    s_cmp_ge_u32 s65, 16
    s_cselect_b64 s[80:81], -1, 0
    v_cndmask_b32_e64 v43, v54, v55, s[80:81]
    ds_bpermute_b32 v44, v42, v43
    s_waitcnt lgkmcnt(0)
    v_and_b32 v18, v44, v14
    v_and_b32 v19, v44, v15
    v_and_b32 v20, v44, v16
    v_and_b32 v21, v44, v17
    s_nop 1
    v_mfma_f32_16x16x32_bf16 v[64:67], v[18:21], v[172:175], v[64:67]
    s_ff1_i32_b32 s65, s70
    s_cmp_eq_u32 s70, 0
    s_cbranch_scc1 LA1_spv_4
    s_bitset0_b32 s70, s65
    s_and_b32 s66, s65, 15
    s_lshl_b32 s66, s66, 2
    v_add_u32 v42, s66, v13
    s_cmp_ge_u32 s65, 16
    s_cselect_b64 s[80:81], -1, 0
    v_cndmask_b32_e64 v43, v54, v55, s[80:81]
    ds_bpermute_b32 v44, v42, v43
    s_waitcnt lgkmcnt(0)
    v_and_b32 v22, v44, v14
    v_and_b32 v23, v44, v15
    v_and_b32 v24, v44, v16
    v_and_b32 v25, v44, v17
    s_nop 1
    v_mfma_f32_16x16x32_bf16 v[64:67], v[22:25], v[176:179], v[64:67]
    s_ff1_i32_b32 s65, s70
    s_cmp_eq_u32 s70, 0
    s_cbranch_scc1 LA1_spv_4
    s_bitset0_b32 s70, s65
    s_and_b32 s66, s65, 15
    s_lshl_b32 s66, s66, 2
    v_add_u32 v42, s66, v13
    s_cmp_ge_u32 s65, 16
    s_cselect_b64 s[80:81], -1, 0
    v_cndmask_b32_e64 v43, v54, v55, s[80:81]
    ds_bpermute_b32 v44, v42, v43
    s_waitcnt lgkmcnt(0)
    v_and_b32 v18, v44, v14
    v_and_b32 v19, v44, v15
    v_and_b32 v20, v44, v16
    v_and_b32 v21, v44, v17
    s_nop 1
    v_mfma_f32_16x16x32_bf16 v[64:67], v[18:21], v[180:183], v[64:67]
    s_ff1_i32_b32 s65, s70
    s_cmp_eq_u32 s70, 0
    s_cbranch_scc1 LA1_spv_4
    s_bitset0_b32 s70, s65
    s_and_b32 s66, s65, 15
    s_lshl_b32 s66, s66, 2
    v_add_u32 v42, s66, v13
    s_cmp_ge_u32 s65, 16
    s_cselect_b64 s[80:81], -1, 0
    v_cndmask_b32_e64 v43, v54, v55, s[80:81]
    ds_bpermute_b32 v44, v42, v43
    s_waitcnt lgkmcnt(0)
    v_and_b32 v22, v44, v14
    v_and_b32 v23, v44, v15
    v_and_b32 v24, v44, v16
    v_and_b32 v25, v44, v17
    s_nop 1
    v_mfma_f32_16x16x32_bf16 v[64:67], v[22:25], v[184:187], v[64:67]
LA1_spv_4:
    s_mov_b32 exec_hi, 0
    s_nop 6
    ds_write_b128 v10, v[64:67] offset:8704
    s_mov_b32 exec_hi, -1
    s_waitcnt lgkmcnt(0)
    s_barrier
    ds_read_b64 v[42:43], v9 offset:8704
    s_waitcnt lgkmcnt(0)
    v_add_f32_dpp v42, v42, v42 row_ror:2 row_mask:0xf bank_mask:0xf
    v_add_f32_dpp v43, v43, v43 row_ror:2 row_mask:0xf bank_mask:0xf
    s_nop 0
    v_add_f32_dpp v42, v42, v42 row_ror:4 row_mask:0xf bank_mask:0xf
    v_add_f32_dpp v43, v43, v43 row_ror:4 row_mask:0xf bank_mask:0xf
    s_nop 0
    v_add_f32_dpp v26, v42, v42 row_ror:8 row_mask:0xf bank_mask:0xf
    v_add_f32_dpp v28, v43, v43 row_ror:8 row_mask:0xf bank_mask:0xf
    s_mov_b64 exec, s[68:69]
    buffer_store_dwordx4 v[26:29], v8, s[56:59], s83 offen sc1
    s_mov_b64 exec, -1
    s_barrier
    buffer_load_dwordx4 v[38:41], v7, s[56:59], 0 offen offset:0 sc1
    s_mov_b64 s[78:79], 0
    buffer_load_dwordx4 v[108:111], v6, s[56:59], 0 offen sc1
    s_waitcnt vmcnt(1)
LA1_chk_5:
    v_cmp_eq_u32 vcc, s29, v39
    v_cmp_eq_u32 s[80:81], s29, v41
    s_and_b64 vcc, vcc, s[80:81]
    s_cmp_eq_u64 vcc, -1
    s_cbranch_scc1 LA1_ok_6
    s_sub_u32 s82, s82, 1
    s_cbranch_scc1 LA1_ok_6
    s_andn2_b64 exec, -1, vcc
    buffer_load_dwordx4 v[38:41], v7, s[56:59], 0 offen offset:0 sc1
    s_mov_b64 exec, -1
    s_waitcnt vmcnt(0)
    s_branch LA1_chk_5
LA1_ok_6:
    v_mov_b32 v42, v38
    s_nop 1
    v_max_f32_dpp v42, v42, v42 row_ror:2 row_mask:0xf bank_mask:0xf
    s_nop 1
    v_max_f32_dpp v42, v42, v42 row_ror:4 row_mask:0xf bank_mask:0xf
    s_nop 1
    v_max_f32_dpp v42, v42, v42 row_ror:8 row_mask:0xf bank_mask:0xf
    v_sub_f32 v43, v38, v42
    v_mul_f32 v43, 0x3fb8aa3b, v43
    v_exp_f32 v43, v43
    s_nop 0
    v_cndmask_b32_e64 v43, 0, v43, s[72:73]
    v_mul_f32 v44, v43, v40
    s_nop 1
    v_add_f32_dpp v44, v44, v44 row_ror:2 row_mask:0xf bank_mask:0xf
    s_nop 1
    v_add_f32_dpp v44, v44, v44 row_ror:4 row_mask:0xf bank_mask:0xf
    s_nop 1
    v_add_f32_dpp v44, v44, v44 row_ror:8 row_mask:0xf bank_mask:0xf
    v_rcp_f32 v44, v44
    s_nop 0
    v_mul_f32 v11, v43, v44
LA1_poll_7:
    s_waitcnt vmcnt(0)
    v_cmp_eq_u32 vcc, s29, v109
    v_cmp_eq_u32 s[80:81], s29, v111
    s_and_b64 vcc, vcc, s[80:81]
    s_andn2_b64 s[18:19], vcc, s[78:79]
    s_or_b64 s[78:79], s[78:79], vcc
    v_cndmask_b32_e64 v30, v30, v108, s[18:19]
    v_cndmask_b32_e64 v32, v32, v110, s[18:19]
    s_cmp_eq_u64 s[78:79], -1
    s_cbranch_scc1 LA1_pdone_8
    s_andn2_b64 exec, -1, s[78:79]
    buffer_load_dwordx4 v[108:111], v6, s[56:59], 0 offen sc1
    s_mov_b64 exec, -1
    s_sub_u32 s82, s82, 1
    s_cbranch_scc0 LA1_poll_7
LA1_pdone_8:
    v_mul_f32 v30, v30, v11
    v_mul_f32 v32, v32, v11
    s_nop 0
    v_add_f32_dpp v30, v30, v30 row_ror:2 row_mask:0xf bank_mask:0xf
    v_add_f32_dpp v32, v32, v32 row_ror:2 row_mask:0xf bank_mask:0xf
    s_nop 0
    v_add_f32_dpp v30, v30, v30 row_ror:4 row_mask:0xf bank_mask:0xf
    v_add_f32_dpp v32, v32, v32 row_ror:4 row_mask:0xf bank_mask:0xf
    s_nop 0
    v_add_f32_dpp v30, v30, v30 row_ror:8 row_mask:0xf bank_mask:0xf
    v_add_f32_dpp v32, v32, v32 row_ror:8 row_mask:0xf bank_mask:0xf
    v_cvt_pk_bf16_f32 v42, v30, v30
    v_cvt_pk_bf16_f32 v43, v32, v32
    s_nop 0
    v_and_b32_dpp v92, v42, v14 quad_perm:[0,0,0,0] row_mask:0xf bank_mask:0xf
    v_and_b32_dpp v93, v42, v15 quad_perm:[0,0,0,0] row_mask:0xf bank_mask:0xf
    v_and_b32_dpp v94, v42, v16 quad_perm:[0,0,0,0] row_mask:0xf bank_mask:0xf
    v_and_b32_dpp v95, v42, v17 quad_perm:[0,0,0,0] row_mask:0xf bank_mask:0xf
    s_nop 1
    v_mfma_f32_16x16x32_bf16 v[64:67], v[92:95], v[76:79], 0
    v_and_b32_dpp v96, v43, v14 quad_perm:[0,0,0,0] row_mask:0xf bank_mask:0xf
    v_and_b32_dpp v97, v43, v15 quad_perm:[0,0,0,0] row_mask:0xf bank_mask:0xf
    v_and_b32_dpp v98, v43, v16 quad_perm:[0,0,0,0] row_mask:0xf bank_mask:0xf
    v_and_b32_dpp v99, v43, v17 quad_perm:[0,0,0,0] row_mask:0xf bank_mask:0xf
    s_nop 1
    v_mfma_f32_16x16x32_bf16 v[64:67], v[96:99], v[80:83], v[64:67]
    v_and_b32_dpp v100, v42, v14 quad_perm:[1,1,1,1] row_mask:0xf bank_mask:0xf
    v_and_b32_dpp v101, v42, v15 quad_perm:[1,1,1,1] row_mask:0xf bank_mask:0xf
    v_and_b32_dpp v102, v42, v16 quad_perm:[1,1,1,1] row_mask:0xf bank_mask:0xf
    v_and_b32_dpp v103, v42, v17 quad_perm:[1,1,1,1] row_mask:0xf bank_mask:0xf
    s_nop 1
    v_mfma_f32_16x16x32_bf16 v[64:67], v[100:103], v[84:87], v[64:67]
    v_and_b32_dpp v104, v43, v14 quad_perm:[1,1,1,1] row_mask:0xf bank_mask:0xf
    v_and_b32_dpp v105, v43, v15 quad_perm:[1,1,1,1] row_mask:0xf bank_mask:0xf
    v_and_b32_dpp v106, v43, v16 quad_perm:[1,1,1,1] row_mask:0xf bank_mask:0xf
    v_and_b32_dpp v107, v43, v17 quad_perm:[1,1,1,1] row_mask:0xf bank_mask:0xf
    s_nop 1
    v_mfma_f32_16x16x32_bf16 v[64:67], v[104:107], v[88:91], v[64:67]
    s_mov_b32 exec_hi, 0
    s_nop 6
    ds_write_b128 v10, v[64:67] offset:0
    s_mov_b32 exec_hi, -1
    s_waitcnt lgkmcnt(0)
    s_barrier
    ds_read_b64 v[42:43], v9 offset:0
    s_waitcnt lgkmcnt(0)
    v_add_f32_dpp v42, v42, v42 row_ror:2 row_mask:0xf bank_mask:0xf
    v_add_f32_dpp v43, v43, v43 row_ror:2 row_mask:0xf bank_mask:0xf
    s_nop 0
    v_add_f32_dpp v42, v42, v42 row_ror:4 row_mask:0xf bank_mask:0xf
    v_add_f32_dpp v43, v43, v43 row_ror:4 row_mask:0xf bank_mask:0xf
    s_nop 0
    v_add_f32_dpp v26, v42, v42 row_ror:8 row_mask:0xf bank_mask:0xf
    v_add_f32_dpp v28, v43, v43 row_ror:8 row_mask:0xf bank_mask:0xf
    s_mov_b64 exec, s[68:69]
    buffer_store_dwordx4 v[26:29], v8, s[56:59], s84 offen sc1
    s_mov_b64 exec, -1
    s_barrier
    s_branch L_final
L_progB:
    s_mov_b32 s64, 24576
    buffer_load_dwordx4 v[88:91], v1, s[36:39], s64 offen nt
    s_waitcnt vmcnt(3)
    s_mov_b32 s64, 32768
    buffer_load_dwordx4 v[92:95], v1, s[36:39], s64 offen nt
    s_waitcnt vmcnt(3)
    s_mov_b32 s64, 40960
    buffer_load_dwordx4 v[96:99], v1, s[36:39], s64 offen nt
    s_waitcnt vmcnt(3)
    s_mov_b32 s64, 49152
    buffer_load_dwordx4 v[100:103], v1, s[36:39], s64 offen nt
    s_waitcnt vmcnt(3)
    s_mov_b32 s64, 57344
    buffer_load_dwordx4 v[104:107], v1, s[36:39], s64 offen nt
    s_waitcnt vmcnt(3)
    s_mov_b32 s64, 65536
    buffer_load_dwordx4 v[108:111], v1, s[36:39], s64 offen nt
    s_waitcnt vmcnt(3)
    s_mov_b32 s64, 73728
    buffer_load_dwordx4 v[112:115], v1, s[36:39], s64 offen nt
    s_waitcnt vmcnt(3)
    s_mov_b32 s64, 81920
    buffer_load_dwordx4 v[116:119], v1, s[36:39], s64 offen nt
    s_waitcnt vmcnt(3)
    s_mov_b32 s64, 90112
    buffer_load_dwordx4 v[120:123], v1, s[36:39], s64 offen nt
    s_waitcnt vmcnt(3)
    s_mov_b32 s64, 98304
    buffer_load_dwordx4 v[124:127], v1, s[36:39], s64 offen nt
    s_waitcnt vmcnt(3)
    s_mov_b32 s64, 106496
    buffer_load_dwordx4 v[128:131], v1, s[36:39], s64 offen nt
    s_waitcnt vmcnt(3)
    s_mov_b32 s64, 114688
    buffer_load_dwordx4 v[132:135], v1, s[36:39], s64 offen nt
    s_waitcnt vmcnt(3)
    s_mov_b32 s64, 122880
    buffer_load_dwordx4 v[136:139], v1, s[36:39], s64 offen nt
    s_waitcnt vmcnt(3)
    buffer_load_dwordx4 v[140:143], v1, s[40:43], 0 offen nt
    s_waitcnt lgkmcnt(0)
    s_mul_i32 s29, s28, 0x9e3779b1
    s_add_u32 s29, s29, 0x7f4a7c15
    v_mov_b32 v27, s29
    v_mov_b32 v29, s29
    v_mov_b32 v35, s29
    v_mov_b32 v37, s29
    buffer_load_dwordx4 v[30:33], v5, s[56:59], 0 offen offset:0 sc1
    s_waitcnt vmcnt(4)
    s_mov_b32 s64, 8192
    buffer_load_dwordx4 v[144:147], v1, s[40:43], s64 offen nt
    s_waitcnt vmcnt(4)
    s_mov_b32 s64, 16384
    buffer_load_dwordx4 v[148:151], v1, s[40:43], s64 offen nt
    s_waitcnt vmcnt(4)
    s_mov_b32 s64, 24576
    buffer_load_dwordx4 v[152:155], v1, s[40:43], s64 offen nt
    s_waitcnt vmcnt(3)
LB_chk_1:
    v_cmp_eq_u32 vcc, s29, v31
    v_cmp_eq_u32 s[80:81], s29, v33
    s_and_b64 vcc, vcc, s[80:81]
    s_cmp_eq_u64 vcc, -1
    s_cbranch_scc1 LB_ok_2
    s_sub_u32 s82, s82, 1
    s_cbranch_scc1 LB_ok_2
    s_andn2_b64 exec, -1, vcc
    buffer_load_dwordx4 v[30:33], v5, s[56:59], 0 offen offset:0 sc1
    s_mov_b64 exec, -1
    s_waitcnt vmcnt(0)
    s_branch LB_chk_1
LB_ok_2:
    v_cndmask_b32_e64 v30, 0, v30, s[24:25]
    v_cndmask_b32_e64 v32, 0, v32, s[24:25]
    s_nop 0
    v_add_f32_dpp v30, v30, v30 row_ror:2 row_mask:0xf bank_mask:0xf
    v_add_f32_dpp v32, v32, v32 row_ror:2 row_mask:0xf bank_mask:0xf
    s_nop 0
    v_add_f32_dpp v30, v30, v30 row_ror:4 row_mask:0xf bank_mask:0xf
    v_add_f32_dpp v32, v32, v32 row_ror:4 row_mask:0xf bank_mask:0xf
    s_nop 0
    v_add_f32_dpp v30, v30, v30 row_ror:8 row_mask:0xf bank_mask:0xf
    v_add_f32_dpp v32, v32, v32 row_ror:8 row_mask:0xf bank_mask:0xf
    v_cvt_pk_bf16_f32 v42, v30, v32
    s_mov_b64 exec, s[68:69]
    ds_write_b32 v72, v42
    s_mov_b64 exec, -1
    s_waitcnt lgkmcnt(0)
    s_barrier
    ds_read_b128 v[60:63], v73
    s_waitcnt lgkmcnt(0)
    v_dot2_f32_bf16 v76, v76, v60, 0
    v_dot2_f32_bf16 v80, v80, v60, 0
    v_dot2_f32_bf16 v84, v84, v60, 0
    v_dot2_f32_bf16 v88, v88, v60, 0
    v_dot2_f32_bf16 v76, v77, v61, v76
    v_dot2_f32_bf16 v80, v81, v61, v80
    v_dot2_f32_bf16 v84, v85, v61, v84
    v_dot2_f32_bf16 v88, v89, v61, v88
    v_dot2_f32_bf16 v76, v78, v62, v76
    v_dot2_f32_bf16 v80, v82, v62, v80
    v_dot2_f32_bf16 v84, v86, v62, v84
    v_dot2_f32_bf16 v88, v90, v62, v88
    v_dot2_f32_bf16 v76, v79, v63, v76
    v_dot2_f32_bf16 v80, v83, v63, v80
    v_dot2_f32_bf16 v84, v87, v63, v84
    v_dot2_f32_bf16 v88, v91, v63, v88
    v_dot2_f32_bf16 v92, v92, v60, 0
    v_dot2_f32_bf16 v96, v96, v60, 0
    v_dot2_f32_bf16 v100, v100, v60, 0
    v_dot2_f32_bf16 v104, v104, v60, 0
    v_dot2_f32_bf16 v92, v93, v61, v92
    v_dot2_f32_bf16 v96, v97, v61, v96
    v_dot2_f32_bf16 v100, v101, v61, v100
    v_dot2_f32_bf16 v104, v105, v61, v104
    v_dot2_f32_bf16 v92, v94, v62, v92
    v_dot2_f32_bf16 v96, v98, v62, v96
    v_dot2_f32_bf16 v100, v102, v62, v100
    v_dot2_f32_bf16 v104, v106, v62, v104
    v_dot2_f32_bf16 v92, v95, v63, v92
    v_dot2_f32_bf16 v96, v99, v63, v96
    v_dot2_f32_bf16 v100, v103, v63, v100
    v_dot2_f32_bf16 v104, v107, v63, v104
    s_mov_b32 s64, 32768
    buffer_load_dwordx4 v[156:159], v1, s[40:43], s64 offen nt
    v_dot2_f32_bf16 v108, v108, v60, 0
    v_dot2_f32_bf16 v112, v112, v60, 0
    v_dot2_f32_bf16 v116, v116, v60, 0
    v_dot2_f32_bf16 v120, v120, v60, 0
    v_dot2_f32_bf16 v108, v109, v61, v108
    v_dot2_f32_bf16 v112, v113, v61, v112
    v_dot2_f32_bf16 v116, v117, v61, v116
    v_dot2_f32_bf16 v120, v121, v61, v120
    v_dot2_f32_bf16 v108, v110, v62, v108
    v_dot2_f32_bf16 v112, v114, v62, v112
    v_dot2_f32_bf16 v116, v118, v62, v116
    v_dot2_f32_bf16 v120, v122, v62, v120
    v_dot2_f32_bf16 v108, v111, v63, v108
    v_dot2_f32_bf16 v112, v115, v63, v112
    v_dot2_f32_bf16 v116, v119, v63, v116
    v_dot2_f32_bf16 v120, v123, v63, v120
    v_dot2_f32_bf16 v124, v124, v60, 0
    v_dot2_f32_bf16 v128, v128, v60, 0
    v_dot2_f32_bf16 v132, v132, v60, 0
    v_dot2_f32_bf16 v136, v136, v60, 0
    v_dot2_f32_bf16 v124, v125, v61, v124
    v_dot2_f32_bf16 v128, v129, v61, v128
    v_dot2_f32_bf16 v132, v133, v61, v132
    v_dot2_f32_bf16 v136, v137, v61, v136
    v_dot2_f32_bf16 v124, v126, v62, v124
    v_dot2_f32_bf16 v128, v130, v62, v128
    v_dot2_f32_bf16 v132, v134, v62, v132
    v_dot2_f32_bf16 v136, v138, v62, v136
    v_dot2_f32_bf16 v124, v127, v63, v124
    v_dot2_f32_bf16 v128, v131, v63, v128
    v_dot2_f32_bf16 v132, v135, v63, v132
    v_dot2_f32_bf16 v136, v139, v63, v136
    v_add_f32_dpp v76, v76, v76 row_ror:8 row_mask:0xf bank_mask:0x3
    v_add_f32_dpp v80, v80, v80 row_ror:8 row_mask:0xf bank_mask:0x3
    v_add_f32_dpp v84, v84, v84 row_ror:8 row_mask:0xf bank_mask:0x3
    v_add_f32_dpp v88, v88, v88 row_ror:8 row_mask:0xf bank_mask:0x3
    v_add_f32_dpp v92, v92, v92 row_ror:8 row_mask:0xf bank_mask:0x3
    v_add_f32_dpp v96, v96, v96 row_ror:8 row_mask:0xf bank_mask:0x3
    v_add_f32_dpp v100, v100, v100 row_ror:8 row_mask:0xf bank_mask:0x3
    v_add_f32_dpp v104, v104, v104 row_ror:8 row_mask:0xf bank_mask:0x3
    v_add_f32_dpp v76, v108, v108 row_ror:8 row_mask:0xf bank_mask:0xc
    v_add_f32_dpp v80, v112, v112 row_ror:8 row_mask:0xf bank_mask:0xc
    v_add_f32_dpp v84, v116, v116 row_ror:8 row_mask:0xf bank_mask:0xc
    v_add_f32_dpp v88, v120, v120 row_ror:8 row_mask:0xf bank_mask:0xc
    v_add_f32_dpp v92, v124, v124 row_ror:8 row_mask:0xf bank_mask:0xc
    v_add_f32_dpp v96, v128, v128 row_ror:8 row_mask:0xf bank_mask:0xc
    v_add_f32_dpp v100, v132, v132 row_ror:8 row_mask:0xf bank_mask:0xc
    v_add_f32_dpp v104, v136, v136 row_ror:8 row_mask:0xf bank_mask:0xc
    v_add_f32_dpp v76, v76, v76 row_half_mirror row_mask:0xf bank_mask:0x5
    v_add_f32_dpp v80, v80, v80 row_half_mirror row_mask:0xf bank_mask:0x5
    v_add_f32_dpp v84, v84, v84 row_half_mirror row_mask:0xf bank_mask:0x5
    v_add_f32_dpp v88, v88, v88 row_half_mirror row_mask:0xf bank_mask:0x5
    v_add_f32_dpp v76, v92, v92 row_half_mirror row_mask:0xf bank_mask:0xa
    v_add_f32_dpp v80, v96, v96 row_half_mirror row_mask:0xf bank_mask:0xa
    v_add_f32_dpp v84, v100, v100 row_half_mirror row_mask:0xf bank_mask:0xa
    v_add_f32_dpp v88, v104, v104 row_half_mirror row_mask:0xf bank_mask:0xa
    v_add_f32_dpp v42, v76, v76 quad_perm:[2,3,0,1] row_mask:0xf bank_mask:0xf
    v_add_f32_dpp v43, v84, v84 quad_perm:[2,3,0,1] row_mask:0xf bank_mask:0xf
    v_add_f32_dpp v44, v80, v80 quad_perm:[2,3,0,1] row_mask:0xf bank_mask:0xf
    v_add_f32_dpp v45, v88, v88 quad_perm:[2,3,0,1] row_mask:0xf bank_mask:0xf
    v_cndmask_b32_e64 v46, v42, v43, s[74:75]
    v_cndmask_b32_e64 v47, v44, v45, s[74:75]
    s_nop 0
    v_add_f32_dpp v42, v46, v46 quad_perm:[1,0,3,2] row_mask:0xf bank_mask:0xf
    v_add_f32_dpp v43, v47, v47 quad_perm:[1,0,3,2] row_mask:0xf bank_mask:0xf
    v_cndmask_b32_e64 v50, v42, v43, s[76:77]
    v_cvt_pk_bf16_f32 v50, v50, v50
    v_and_b32 v50, 0xffff0000, v50
    v_mul_f32 v50, 0x3db504f3, v50
    v_cvt_pk_bf16_f32 v50, v50, v50
    v_and_b32 v50, 0xffff0000, v50
    v_mov_b32 v12, v50
    s_nop 1
    v_max_f32_dpp v12, v12, v12 row_ror:1 row_mask:0xf bank_mask:0xf
    s_nop 1
    v_max_f32_dpp v12, v12, v12 row_ror:2 row_mask:0xf bank_mask:0xf
    s_nop 1
    v_max_f32_dpp v12, v12, v12 row_ror:4 row_mask:0xf bank_mask:0xf
    s_nop 1
    v_max_f32_dpp v12, v12, v12 row_ror:8 row_mask:0xf bank_mask:0xf
    v_mov_b32 v42, v12
    s_nop 1
    v_permlane16_swap_b32 v12, v42
    v_max_f32 v12, v12, v42
    v_mov_b32 v42, v12
    s_nop 1
    v_permlane32_swap_b32 v12, v42
    v_max_f32 v12, v12, v42
    v_sub_f32 v52, v50, v12
    v_mul_f32 v50, 0x3fb8aa3b, v52
    v_exp_f32 v50, v50
    s_nop 0
    v_mov_b32 v43, v50
    s_nop 1
    v_add_f32_dpp v43, v43, v43 row_ror:1 row_mask:0xf bank_mask:0xf
    s_nop 1
    v_add_f32_dpp v43, v43, v43 row_ror:2 row_mask:0xf bank_mask:0xf
    s_nop 1
    v_add_f32_dpp v43, v43, v43 row_ror:4 row_mask:0xf bank_mask:0xf
    s_nop 1
    v_add_f32_dpp v43, v43, v43 row_ror:8 row_mask:0xf bank_mask:0xf
    v_mov_b32 v44, v43
    s_nop 1
    v_permlane16_swap_b32 v43, v44
    v_add_f32 v43, v43, v44
    v_mov_b32 v44, v43
    s_nop 1
    v_permlane32_swap_b32 v43, v44
    v_add_f32 v43, v43, v44
    v_mov_b32 v42, v12
    v_mov_b32 v44, s30
    v_lshlrev_b32 v44, 3, v44
    s_mov_b64 exec, 1
    ds_write_b64 v44, v[42:43] offset:22016
    s_mov_b64 exec, -1
    s_waitcnt vmcnt(3)
    s_mov_b32 s64, 40960
    buffer_load_dwordx4 v[160:163], v1, s[40:43], s64 offen nt
    s_waitcnt lgkmcnt(0)
    s_barrier
    v_and_b32 v44, 7, v0
    v_lshlrev_b32 v44, 3, v44
    ds_read_b64 v[42:43], v44 offset:22016
    s_waitcnt lgkmcnt(0)
    v_max_f32_dpp v44, v42, v42 quad_perm:[1,0,3,2] row_mask:0xf bank_mask:0xf
    s_nop 1
    v_max_f32_dpp v44, v44, v44 quad_perm:[2,3,0,1] row_mask:0xf bank_mask:0xf
    s_nop 1
    v_max_f32_dpp v44, v44, v44 row_half_mirror row_mask:0xf bank_mask:0xf
    v_sub_f32 v46, v12, v44
    v_sub_f32 v45, v42, v44
    v_mul_f32 v45, 0x3fb8aa3b, v45
    v_mul_f32 v46, 0x3fb8aa3b, v46
    v_exp_f32 v45, v45
    v_exp_f32 v46, v46
    v_mul_f32 v45, v45, v43
    v_mul_f32 v50, v50, v46
    s_nop 0
    v_add_f32_dpp v45, v45, v45 quad_perm:[1,0,3,2] row_mask:0xf bank_mask:0xf
    v_cvt_pk_bf16_f32 v54, v50, v50
    s_nop 0
    v_add_f32_dpp v45, v45, v45 quad_perm:[2,3,0,1] row_mask:0xf bank_mask:0xf
    s_nop 1
    v_add_f32_dpp v28, v45, v45 row_half_mirror row_mask:0xf bank_mask:0xf
    v_mov_b32 v26, v44
    v_mov_b32 v47, 1024
    s_mov_b64 exec, 1
    buffer_store_dwordx4 v[26:29], v47, s[56:59], s83 offen sc1
    s_mov_b64 exec, -1
    v_and_b32_dpp v18, v54, v14 row_newbcast:0 row_mask:0xf bank_mask:0xf
    v_and_b32_dpp v19, v54, v15 row_newbcast:0 row_mask:0xf bank_mask:0xf
    v_and_b32_dpp v20, v54, v16 row_newbcast:0 row_mask:0xf bank_mask:0xf
    v_and_b32_dpp v21, v54, v17 row_newbcast:0 row_mask:0xf bank_mask:0xf
    s_nop 1
    v_mfma_f32_16x16x32_bf16 v[64:67], v[18:21], v[140:143], 0
    v_and_b32_dpp v22, v54, v14 row_newbcast:1 row_mask:0xf bank_mask:0xf
    v_and_b32_dpp v23, v54, v15 row_newbcast:1 row_mask:0xf bank_mask:0xf
    v_and_b32_dpp v24, v54, v16 row_newbcast:1 row_mask:0xf bank_mask:0xf
    v_and_b32_dpp v25, v54, v17 row_newbcast:1 row_mask:0xf bank_mask:0xf
    s_nop 1
    v_mfma_f32_16x16x32_bf16 v[64:67], v[22:25], v[144:147], v[64:67]
    s_waitcnt vmcnt(4)
    s_mov_b32 s64, 49152
    buffer_load_dwordx4 v[164:167], v1, s[40:43], s64 offen nt
    v_and_b32_dpp v18, v54, v14 row_newbcast:2 row_mask:0xf bank_mask:0xf
    v_and_b32_dpp v19, v54, v15 row_newbcast:2 row_mask:0xf bank_mask:0xf
    v_and_b32_dpp v20, v54, v16 row_newbcast:2 row_mask:0xf bank_mask:0xf
    v_and_b32_dpp v21, v54, v17 row_newbcast:2 row_mask:0xf bank_mask:0xf
    s_nop 1
    v_mfma_f32_16x16x32_bf16 v[64:67], v[18:21], v[148:151], v[64:67]
    s_waitcnt vmcnt(4)
    s_mov_b32 s64, 57344
    buffer_load_dwordx4 v[168:171], v1, s[40:43], s64 offen nt
    v_and_b32_dpp v22, v54, v14 row_newbcast:3 row_mask:0xf bank_mask:0xf
    v_and_b32_dpp v23, v54, v15 row_newbcast:3 row_mask:0xf bank_mask:0xf
    v_and_b32_dpp v24, v54, v16 row_newbcast:3 row_mask:0xf bank_mask:0xf
    v_and_b32_dpp v25, v54, v17 row_newbcast:3 row_mask:0xf bank_mask:0xf
    s_nop 1
    v_mfma_f32_16x16x32_bf16 v[64:67], v[22:25], v[152:155], v[64:67]
    s_waitcnt vmcnt(4)
    s_mov_b32 s64, 65536
    buffer_load_dwordx4 v[172:175], v1, s[40:43], s64 offen nt
    v_and_b32_dpp v18, v54, v14 row_newbcast:4 row_mask:0xf bank_mask:0xf
    v_and_b32_dpp v19, v54, v15 row_newbcast:4 row_mask:0xf bank_mask:0xf
    v_and_b32_dpp v20, v54, v16 row_newbcast:4 row_mask:0xf bank_mask:0xf
    v_and_b32_dpp v21, v54, v17 row_newbcast:4 row_mask:0xf bank_mask:0xf
    s_nop 1
    v_mfma_f32_16x16x32_bf16 v[64:67], v[18:21], v[156:159], v[64:67]
    s_waitcnt vmcnt(4)
    s_mov_b32 s64, 73728
    buffer_load_dwordx4 v[176:179], v1, s[40:43], s64 offen nt
    v_and_b32_dpp v22, v54, v14 row_newbcast:5 row_mask:0xf bank_mask:0xf
    v_and_b32_dpp v23, v54, v15 row_newbcast:5 row_mask:0xf bank_mask:0xf
    v_and_b32_dpp v24, v54, v16 row_newbcast:5 row_mask:0xf bank_mask:0xf
    v_and_b32_dpp v25, v54, v17 row_newbcast:5 row_mask:0xf bank_mask:0xf
    s_nop 1
    v_mfma_f32_16x16x32_bf16 v[64:67], v[22:25], v[160:163], v[64:67]
    s_waitcnt vmcnt(3)
    s_mov_b32 s64, 81920
    buffer_load_dwordx4 v[180:183], v1, s[40:43], s64 offen nt
    v_and_b32_dpp v18, v54, v14 row_newbcast:6 row_mask:0xf bank_mask:0xf
    v_and_b32_dpp v19, v54, v15 row_newbcast:6 row_mask:0xf bank_mask:0xf
    v_and_b32_dpp v20, v54, v16 row_newbcast:6 row_mask:0xf bank_mask:0xf
    v_and_b32_dpp v21, v54, v17 row_newbcast:6 row_mask:0xf bank_mask:0xf
    s_nop 1
    v_mfma_f32_16x16x32_bf16 v[64:67], v[18:21], v[164:167], v[64:67]
    s_waitcnt vmcnt(3)
    s_mov_b32 s64, 90112
    buffer_load_dwordx4 v[184:187], v1, s[40:43], s64 offen nt
    v_and_b32_dpp v22, v54, v14 row_newbcast:7 row_mask:0xf bank_mask:0xf
    v_and_b32_dpp v23, v54, v15 row_newbcast:7 row_mask:0xf bank_mask:0xf
    v_and_b32_dpp v24, v54, v16 row_newbcast:7 row_mask:0xf bank_mask:0xf
    v_and_b32_dpp v25, v54, v17 row_newbcast:7 row_mask:0xf bank_mask:0xf
    s_nop 1
    v_mfma_f32_16x16x32_bf16 v[64:67], v[22:25], v[168:171], v[64:67]
    s_waitcnt vmcnt(3)
    s_mov_b32 s64, 98304
    buffer_load_dwordx4 v[188:191], v1, s[40:43], s64 offen nt
    v_and_b32_dpp v18, v54, v14 row_newbcast:8 row_mask:0xf bank_mask:0xf
    v_and_b32_dpp v19, v54, v15 row_newbcast:8 row_mask:0xf bank_mask:0xf
    v_and_b32_dpp v20, v54, v16 row_newbcast:8 row_mask:0xf bank_mask:0xf
    v_and_b32_dpp v21, v54, v17 row_newbcast:8 row_mask:0xf bank_mask:0xf
    s_nop 1
    v_mfma_f32_16x16x32_bf16 v[64:67], v[18:21], v[172:175], v[64:67]
    s_waitcnt vmcnt(3)
    s_mov_b32 s64, 106496
    buffer_load_dwordx4 v[192:195], v1, s[40:43], s64 offen nt
    v_and_b32_dpp v22, v54, v14 row_newbcast:9 row_mask:0xf bank_mask:0xf
    v_and_b32_dpp v23, v54, v15 row_newbcast:9 row_mask:0xf bank_mask:0xf
    v_and_b32_dpp v24, v54, v16 row_newbcast:9 row_mask:0xf bank_mask:0xf
    v_and_b32_dpp v25, v54, v17 row_newbcast:9 row_mask:0xf bank_mask:0xf
    s_nop 1
    v_mfma_f32_16x16x32_bf16 v[64:67], v[22:25], v[176:179], v[64:67]
    s_waitcnt vmcnt(3)
    s_mov_b32 s64, 114688
    buffer_load_dwordx4 v[196:199], v1, s[40:43], s64 offen nt
    v_and_b32_dpp v18, v54, v14 row_newbcast:10 row_mask:0xf bank_mask:0xf
    v_and_b32_dpp v19, v54, v15 row_newbcast:10 row_mask:0xf bank_mask:0xf
    v_and_b32_dpp v20, v54, v16 row_newbcast:10 row_mask:0xf bank_mask:0xf
    v_and_b32_dpp v21, v54, v17 row_newbcast:10 row_mask:0xf bank_mask:0xf
    s_nop 1
    v_mfma_f32_16x16x32_bf16 v[64:67], v[18:21], v[180:183], v[64:67]
    s_waitcnt vmcnt(3)
    s_mov_b32 s64, 122880
    buffer_load_dwordx4 v[200:203], v1, s[40:43], s64 offen nt
    v_and_b32_dpp v22, v54, v14 row_newbcast:11 row_mask:0xf bank_mask:0xf
    v_and_b32_dpp v23, v54, v15 row_newbcast:11 row_mask:0xf bank_mask:0xf
    v_and_b32_dpp v24, v54, v16 row_newbcast:11 row_mask:0xf bank_mask:0xf
    v_and_b32_dpp v25, v54, v17 row_newbcast:11 row_mask:0xf bank_mask:0xf
    s_nop 1
    v_mfma_f32_16x16x32_bf16 v[64:67], v[22:25], v[184:187], v[64:67]
    s_waitcnt vmcnt(3)
    buffer_load_dwordx4 v[204:207], v3, s[48:51], 0 offen offset:0 nt
    v_and_b32_dpp v18, v54, v14 row_newbcast:12 row_mask:0xf bank_mask:0xf
    v_and_b32_dpp v19, v54, v15 row_newbcast:12 row_mask:0xf bank_mask:0xf
    v_and_b32_dpp v20, v54, v16 row_newbcast:12 row_mask:0xf bank_mask:0xf
    v_and_b32_dpp v21, v54, v17 row_newbcast:12 row_mask:0xf bank_mask:0xf
    s_nop 1
    v_mfma_f32_16x16x32_bf16 v[64:67], v[18:21], v[188:191], v[64:67]
    s_waitcnt vmcnt(3)
    buffer_load_dwordx4 v[208:211], v3, s[48:51], 0 offen offset:1280 nt
    v_and_b32_dpp v22, v54, v14 row_newbcast:13 row_mask:0xf bank_mask:0xf
    v_and_b32_dpp v23, v54, v15 row_newbcast:13 row_mask:0xf bank_mask:0xf
    v_and_b32_dpp v24, v54, v16 row_newbcast:13 row_mask:0xf bank_mask:0xf
    v_and_b32_dpp v25, v54, v17 row_newbcast:13 row_mask:0xf bank_mask:0xf
    s_nop 1
    v_mfma_f32_16x16x32_bf16 v[64:67], v[22:25], v[192:195], v[64:67]
    s_waitcnt vmcnt(3)
    buffer_load_dwordx4 v[212:215], v3, s[48:51], 0 offen offset:2560 nt
    v_and_b32_dpp v18, v54, v14 row_newbcast:14 row_mask:0xf bank_mask:0xf
    v_and_b32_dpp v19, v54, v15 row_newbcast:14 row_mask:0xf bank_mask:0xf
    v_and_b32_dpp v20, v54, v16 row_newbcast:14 row_mask:0xf bank_mask:0xf
    v_and_b32_dpp v21, v54, v17 row_newbcast:14 row_mask:0xf bank_mask:0xf
    s_nop 1
    v_mfma_f32_16x16x32_bf16 v[64:67], v[18:21], v[196:199], v[64:67]
    s_waitcnt vmcnt(3)
    buffer_load_dwordx4 v[216:219], v3, s[48:51], 0 offen offset:3840 nt
    v_and_b32_dpp v22, v54, v14 row_newbcast:15 row_mask:0xf bank_mask:0xf
    v_and_b32_dpp v23, v54, v15 row_newbcast:15 row_mask:0xf bank_mask:0xf
    v_and_b32_dpp v24, v54, v16 row_newbcast:15 row_mask:0xf bank_mask:0xf
    v_and_b32_dpp v25, v54, v17 row_newbcast:15 row_mask:0xf bank_mask:0xf
    s_nop 1
    v_mfma_f32_16x16x32_bf16 v[64:67], v[22:25], v[200:203], v[64:67]
    s_mov_b32 exec_hi, 0
    s_nop 6
    ds_write_b128 v10, v[64:67] offset:8704
    s_mov_b32 exec_hi, -1
    s_waitcnt lgkmcnt(0)
    s_barrier
    ds_read_b64 v[42:43], v9 offset:8704
    s_waitcnt lgkmcnt(0)
    v_add_f32_dpp v42, v42, v42 row_ror:2 row_mask:0xf bank_mask:0xf
    v_add_f32_dpp v43, v43, v43 row_ror:2 row_mask:0xf bank_mask:0xf
    s_nop 0
    v_add_f32_dpp v42, v42, v42 row_ror:4 row_mask:0xf bank_mask:0xf
    v_add_f32_dpp v43, v43, v43 row_ror:4 row_mask:0xf bank_mask:0xf
    s_nop 0
    v_add_f32_dpp v26, v42, v42 row_ror:8 row_mask:0xf bank_mask:0xf
    v_add_f32_dpp v28, v43, v43 row_ror:8 row_mask:0xf bank_mask:0xf
    s_mov_b64 exec, s[68:69]
    buffer_store_dwordx4 v[26:29], v8, s[56:59], s83 offen sc1
    s_mov_b64 exec, -1
    s_barrier
    s_movk_i32 s64, 256
    buffer_load_dwordx4 v[220:223], v3, s[48:51], s64 offen offset:0 nt
    s_movk_i32 s64, 256
    buffer_load_dwordx4 v[224:227], v3, s[48:51], s64 offen offset:1280 nt
    s_movk_i32 s64, 256
    buffer_load_dwordx4 v[228:231], v3, s[48:51], s64 offen offset:2560 nt
    s_movk_i32 s64, 256
    buffer_load_dwordx4 v[232:235], v3, s[48:51], s64 offen offset:3840 nt
    buffer_load_dwordx4 v[38:41], v7, s[56:59], 0 offen offset:0 sc1
    s_mov_b64 s[78:79], 0
    buffer_load_dwordx4 v[92:95], v6, s[56:59], 0 offen sc1
    s_waitcnt vmcnt(1)
LB_chk_3:
    v_cmp_eq_u32 vcc, s29, v39
    v_cmp_eq_u32 s[80:81], s29, v41
    s_and_b64 vcc, vcc, s[80:81]
    s_cmp_eq_u64 vcc, -1
    s_cbranch_scc1 LB_ok_4
    s_sub_u32 s82, s82, 1
    s_cbranch_scc1 LB_ok_4
    s_andn2_b64 exec, -1, vcc
    buffer_load_dwordx4 v[38:41], v7, s[56:59], 0 offen offset:0 sc1
    s_mov_b64 exec, -1
    s_waitcnt vmcnt(0)
    s_branch LB_chk_3
LB_ok_4:
    v_mov_b32 v42, v38
    s_nop 1
    v_max_f32_dpp v42, v42, v42 row_ror:2 row_mask:0xf bank_mask:0xf
    s_nop 1
    v_max_f32_dpp v42, v42, v42 row_ror:4 row_mask:0xf bank_mask:0xf
    s_nop 1
    v_max_f32_dpp v42, v42, v42 row_ror:8 row_mask:0xf bank_mask:0xf
    v_sub_f32 v43, v38, v42
    v_mul_f32 v43, 0x3fb8aa3b, v43
    v_exp_f32 v43, v43
    s_nop 0
    v_cndmask_b32_e64 v43, 0, v43, s[72:73]
    v_mul_f32 v44, v43, v40
    s_nop 1
    v_add_f32_dpp v44, v44, v44 row_ror:2 row_mask:0xf bank_mask:0xf
    s_nop 1
    v_add_f32_dpp v44, v44, v44 row_ror:4 row_mask:0xf bank_mask:0xf
    s_nop 1
    v_add_f32_dpp v44, v44, v44 row_ror:8 row_mask:0xf bank_mask:0xf
    v_rcp_f32 v44, v44
    s_nop 0
    v_mul_f32 v11, v43, v44
LB_poll_5:
    s_waitcnt vmcnt(0)
    v_cmp_eq_u32 vcc, s29, v93
    v_cmp_eq_u32 s[80:81], s29, v95
    s_and_b64 vcc, vcc, s[80:81]
    s_andn2_b64 s[18:19], vcc, s[78:79]
    s_or_b64 s[78:79], s[78:79], vcc
    v_cndmask_b32_e64 v30, v30, v92, s[18:19]
    v_cndmask_b32_e64 v32, v32, v94, s[18:19]
    s_cmp_eq_u64 s[78:79], -1
    s_cbranch_scc1 LB_pdone_6
    s_andn2_b64 exec, -1, s[78:79]
    buffer_load_dwordx4 v[92:95], v6, s[56:59], 0 offen sc1
    s_mov_b64 exec, -1
    s_sub_u32 s82, s82, 1
    s_cbranch_scc0 LB_poll_5
LB_pdone_6:
    v_mul_f32 v30, v30, v11
    v_mul_f32 v32, v32, v11
    s_nop 0
    v_add_f32_dpp v30, v30, v30 row_ror:2 row_mask:0xf bank_mask:0xf
    v_add_f32_dpp v32, v32, v32 row_ror:2 row_mask:0xf bank_mask:0xf
    s_nop 0
    v_add_f32_dpp v30, v30, v30 row_ror:4 row_mask:0xf bank_mask:0xf
    v_add_f32_dpp v32, v32, v32 row_ror:4 row_mask:0xf bank_mask:0xf
    s_nop 0
    v_add_f32_dpp v30, v30, v30 row_ror:8 row_mask:0xf bank_mask:0xf
    v_add_f32_dpp v32, v32, v32 row_ror:8 row_mask:0xf bank_mask:0xf
    v_cvt_pk_bf16_f32 v42, v30, v30
    v_cvt_pk_bf16_f32 v43, v32, v32
    s_nop 0
    v_and_b32_dpp v76, v42, v14 quad_perm:[0,0,0,0] row_mask:0xf bank_mask:0xf
    v_and_b32_dpp v77, v42, v15 quad_perm:[0,0,0,0] row_mask:0xf bank_mask:0xf
    v_and_b32_dpp v78, v42, v16 quad_perm:[0,0,0,0] row_mask:0xf bank_mask:0xf
    v_and_b32_dpp v79, v42, v17 quad_perm:[0,0,0,0] row_mask:0xf bank_mask:0xf
    s_nop 1
    v_mfma_f32_16x16x32_bf16 v[64:67], v[76:79], v[204:207], 0
    v_mfma_f32_16x16x32_bf16 v[68:71], v[76:79], v[220:223], 0
    v_and_b32_dpp v80, v43, v14 quad_perm:[0,0,0,0] row_mask:0xf bank_mask:0xf
    v_and_b32_dpp v81, v43, v15 quad_perm:[0,0,0,0] row_mask:0xf bank_mask:0xf
    v_and_b32_dpp v82, v43, v16 quad_perm:[0,0,0,0] row_mask:0xf bank_mask:0xf
    v_and_b32_dpp v83, v43, v17 quad_perm:[0,0,0,0] row_mask:0xf bank_mask:0xf
    s_nop 1
    v_mfma_f32_16x16x32_bf16 v[64:67], v[80:83], v[208:211], v[64:67]
    v_mfma_f32_16x16x32_bf16 v[68:71], v[80:83], v[224:227], v[68:71]
    v_and_b32_dpp v84, v42, v14 quad_perm:[1,1,1,1] row_mask:0xf bank_mask:0xf
    v_and_b32_dpp v85, v42, v15 quad_perm:[1,1,1,1] row_mask:0xf bank_mask:0xf
    v_and_b32_dpp v86, v42, v16 quad_perm:[1,1,1,1] row_mask:0xf bank_mask:0xf
    v_and_b32_dpp v87, v42, v17 quad_perm:[1,1,1,1] row_mask:0xf bank_mask:0xf
    s_nop 1
    v_mfma_f32_16x16x32_bf16 v[64:67], v[84:87], v[212:215], v[64:67]
    v_mfma_f32_16x16x32_bf16 v[68:71], v[84:87], v[228:231], v[68:71]
    v_and_b32_dpp v88, v43, v14 quad_perm:[1,1,1,1] row_mask:0xf bank_mask:0xf
    v_and_b32_dpp v89, v43, v15 quad_perm:[1,1,1,1] row_mask:0xf bank_mask:0xf
    v_and_b32_dpp v90, v43, v16 quad_perm:[1,1,1,1] row_mask:0xf bank_mask:0xf
    v_and_b32_dpp v91, v43, v17 quad_perm:[1,1,1,1] row_mask:0xf bank_mask:0xf
    s_nop 1
    v_mfma_f32_16x16x32_bf16 v[64:67], v[88:91], v[216:219], v[64:67]
    v_mfma_f32_16x16x32_bf16 v[68:71], v[88:91], v[232:235], v[68:71]
    s_mov_b32 exec_hi, 0
    s_nop 5
    ds_write_b128 v10, v[64:67] offset:0
    s_mov_b32 exec_hi, -1
    s_mov_b32 exec_hi, 0
    ds_write_b128 v10, v[68:71] offset:4352
    s_mov_b32 exec_hi, -1
    s_waitcnt lgkmcnt(0)
    s_barrier
    s_add_u32 s5, s84, 32768
    ds_read_b64 v[42:43], v9 offset:0
    ds_read_b64 v[44:45], v9 offset:4352
    s_waitcnt lgkmcnt(1)
    v_add_f32_dpp v42, v42, v42 row_ror:2 row_mask:0xf bank_mask:0xf
    v_add_f32_dpp v43, v43, v43 row_ror:2 row_mask:0xf bank_mask:0xf
    s_nop 0
    v_add_f32_dpp v42, v42, v42 row_ror:4 row_mask:0xf bank_mask:0xf
    v_add_f32_dpp v43, v43, v43 row_ror:4 row_mask:0xf bank_mask:0xf
    s_nop 0
    v_add_f32_dpp v26, v42, v42 row_ror:8 row_mask:0xf bank_mask:0xf
    v_add_f32_dpp v28, v43, v43 row_ror:8 row_mask:0xf bank_mask:0xf
    s_mov_b64 exec, s[68:69]
    buffer_store_dwordx4 v[26:29], v8, s[56:59], s84 offen sc1
    s_mov_b64 exec, -1
    s_waitcnt lgkmcnt(0)
    v_add_f32_dpp v44, v44, v44 row_ror:2 row_mask:0xf bank_mask:0xf
    v_add_f32_dpp v45, v45, v45 row_ror:2 row_mask:0xf bank_mask:0xf
    s_nop 0
    v_add_f32_dpp v44, v44, v44 row_ror:4 row_mask:0xf bank_mask:0xf
    v_add_f32_dpp v45, v45, v45 row_ror:4 row_mask:0xf bank_mask:0xf
    s_nop 0
    v_add_f32_dpp v34, v44, v44 row_ror:8 row_mask:0xf bank_mask:0xf
    v_add_f32_dpp v36, v45, v45 row_ror:8 row_mask:0xf bank_mask:0xf
    s_mov_b64 exec, s[68:69]
    buffer_store_dwordx4 v[34:37], v8, s[56:59], s5 offen sc1
    s_mov_b64 exec, -1
    s_barrier
    s_branch L_final
L_final:
    s_lshl_b32 s65, s30, 8
    s_add_u32 s65, s65, s2
    s_cmp_ge_u32 s65, 320
    s_cbranch_scc1 L_fin_done
    s_lshr_b32 s66, s65, 5
    s_and_b32 s67, s65, 31
    s_lshl_b32 s64, s66, 15
    s_lshl_b32 s83, s67, 5
    s_add_u32 s64, s64, s83
    s_add_u32 s64, s64, 1118208
    v_lshrrev_b32 v2, 1, v0
    v_and_b32 v3, 1, v0
    v_lshlrev_b32 v2, 10, v2
    v_lshl_add_u32 v2, v3, 4, v2
    v_add_u32 v2, s64, v2
    s_cmp_lg_u32 s65, 0
    s_cbranch_scc1 L_fin_main
    v_add_u32 v6, 163840, v2
    s_mov_b64 s[78:79], 0
    buffer_load_dwordx4 v[216:219], v6, s[56:59], 0 offen sc1
    buffer_load_dwordx4 v[220:223], v6, s[56:59], 0 offen sc1
LF_poll_1:
    s_waitcnt vmcnt(1)
    v_cmp_eq_u32 vcc, s29, v217
    v_cmp_eq_u32 s[80:81], s29, v219
    s_and_b64 vcc, vcc, s[80:81]
    s_andn2_b64 s[18:19], vcc, s[78:79]
    s_or_b64 s[78:79], s[78:79], vcc
    v_cndmask_b32_e64 v4, v4, v216, s[18:19]
    v_cndmask_b32_e64 v5, v5, v218, s[18:19]
    s_cmp_eq_u64 s[78:79], -1
    s_cbranch_scc1 LF_pdone_2
    s_andn2_b64 exec, -1, s[78:79]
    buffer_load_dwordx4 v[216:219], v6, s[56:59], 0 offen sc1
    s_mov_b64 exec, -1
    s_waitcnt vmcnt(1)
    v_cmp_eq_u32 vcc, s29, v221
    v_cmp_eq_u32 s[80:81], s29, v223
    s_and_b64 vcc, vcc, s[80:81]
    s_andn2_b64 s[18:19], vcc, s[78:79]
    s_or_b64 s[78:79], s[78:79], vcc
    v_cndmask_b32_e64 v4, v4, v220, s[18:19]
    v_cndmask_b32_e64 v5, v5, v222, s[18:19]
    s_cmp_eq_u64 s[78:79], -1
    s_cbranch_scc1 LF_pdone_2
    s_andn2_b64 exec, -1, s[78:79]
    buffer_load_dwordx4 v[220:223], v6, s[56:59], 0 offen sc1
    s_mov_b64 exec, -1
    s_sub_u32 s82, s82, 1
    s_cbranch_scc0 LF_poll_1
LF_pdone_2:
L_fin_main:
    s_mov_b64 s[78:79], 0
    buffer_load_dwordx4 v[200:203], v2, s[56:59], 0 offen sc1
LF_poll_3:
    s_waitcnt vmcnt(0)
    v_cmp_eq_u32 vcc, s29, v201
    v_cmp_eq_u32 s[80:81], s29, v203
    s_and_b64 vcc, vcc, s[80:81]
    s_andn2_b64 s[18:19], vcc, s[78:79]
    s_or_b64 s[78:79], s[78:79], vcc
    v_cndmask_b32_e64 v4, v4, v200, s[18:19]
    v_cndmask_b32_e64 v5, v5, v202, s[18:19]
    s_cmp_eq_u64 s[78:79], -1
    s_cbranch_scc1 LF_pdone_4
    s_andn2_b64 exec, -1, s[78:79]
    buffer_load_dwordx4 v[200:203], v2, s[56:59], 0 offen sc1
    s_mov_b64 exec, -1
    s_sub_u32 s82, s82, 1
    s_cbranch_scc0 LF_poll_3
LF_pdone_4:
    v_add_f32_dpp v4, v4, v4 row_ror:2 row_mask:0xf bank_mask:0xf
    v_add_f32_dpp v5, v5, v5 row_ror:2 row_mask:0xf bank_mask:0xf
    s_nop 0
    v_add_f32_dpp v4, v4, v4 row_ror:4 row_mask:0xf bank_mask:0xf
    v_add_f32_dpp v5, v5, v5 row_ror:4 row_mask:0xf bank_mask:0xf
    s_nop 0
    v_add_f32_dpp v4, v4, v4 row_ror:8 row_mask:0xf bank_mask:0xf
    v_add_f32_dpp v5, v5, v5 row_ror:8 row_mask:0xf bank_mask:0xf
    v_mov_b32 v6, v4
    v_mov_b32 v7, v5
    s_nop 0
    v_permlane16_swap_b32 v4, v6
    v_permlane16_swap_b32 v5, v7
    v_add_f32 v4, v4, v6
    v_add_f32 v5, v5, v7
    v_mov_b32 v6, v4
    v_mov_b32 v7, v5
    s_nop 0
    v_permlane32_swap_b32 v4, v6
    v_permlane32_swap_b32 v5, v7
    v_add_f32 v4, v4, v6
    v_add_f32 v5, v5, v7
    v_cvt_pk_bf16_f32 v4, v4, v5
    s_lshl_b32 s64, s66, 8
    s_lshl_b32 s83, s67, 3
    s_add_u32 s64, s64, s83
    v_lshlrev_b32 v3, 2, v3
    v_add_u32 v3, s64, v3
    s_mov_b64 exec, 3
    buffer_store_dword v4, v3, s[60:63], 0 offen sc1
    s_cmp_eq_u32 s65, 0
    s_cbranch_scc0 L_fin_noep
    s_mov_b64 exec, 1
    v_mov_b32 v8, s29
    v_mov_b32 v9, 0
    buffer_store_dword v8, v9, s[56:59], 0 offen sc1
L_fin_noep:
    s_mov_b64 exec, -1
L_fin_done:
L_end:
    s_endpgm

    .fill 1536, 4, 0xbf800000
.section .rodata,"a"
.p2align 6
.amdhsa_kernel concat_heads__gqa_block_cached__sliding_block_cached__decode_kernel
  .amdhsa_next_free_vgpr 256
  .amdhsa_next_free_sgpr 102
  .amdhsa_accum_offset 256
  .amdhsa_group_segment_fixed_size 0
  .amdhsa_kernarg_size 104
  .amdhsa_user_sgpr_count 2
  .amdhsa_user_sgpr_kernarg_segment_ptr 1
  .amdhsa_system_sgpr_workgroup_id_x 1
.end_amdhsa_kernel
```
